```python
import torch

def _softmax(x, axis=-1):
    return torch.softmax(x, dim=axis)
def _gelu(x):
    return torch.nn.functional.gelu(x, approximate="tanh")
def _silu(x):
    return torch.nn.functional.silu(x)
def _sigmoid(x):
    return torch.sigmoid(x)
def _layernorm(x, axis=-1, eps=1e-5):
    m = x.mean(dim=axis, keepdim=True)
    v = x.var(dim=axis, keepdim=True, unbiased=False)
    return (x - m) / torch.sqrt(v + eps)
def _scatter_add(tgt, idx, src, axis=0):
    return tgt.clone().index_add_(axis, idx, src)
def _segment_sum(src, seg, n):
    out = torch.zeros((n,) + src.shape[1:], dtype=src.dtype)
    return out.index_add_(0, seg, src)
def _pad(x, pw):
    flat = tuple(v for pair in reversed(pw) for v in pair)
    return torch.nn.functional.pad(x, flat)

kernel_name = 'recurrent_scan__ssm_conv_s5__mixer_token_mlp__prompt'

def setup_inputs():

    _w = (lambda a: (lambda t: t.to(torch.bfloat16) if t.is_floating_point() else t)(torch.as_tensor(a)))
    def _A_setup():
        B, S, D = 1, 2048, 512
        P = D
        Lambda_re = -0.5 * (lambda _x: torch.exp(torch.as_tensor(_x)))((lambda *s: torch.randn(*s, dtype=torch.bfloat16) * 0.4)(P))
        Lambda_im = (lambda *s: torch.randn(*s, dtype=torch.bfloat16) * 0.8)(P) * 1.0
        B_re = (lambda *s: torch.randn(*s, dtype=torch.bfloat16) * 0.4)(P, D) * (D ** -0.5)
        B_im = (lambda *s: torch.randn(*s, dtype=torch.bfloat16) * 0.4)(P, D) * (D ** -0.5)
        C_re = (lambda *s: torch.randn(*s, dtype=torch.bfloat16) * 0.4)(D, P) * (P ** -0.5)
        C_im = (lambda *s: torch.randn(*s, dtype=torch.bfloat16) * 0.4)(D, P) * (P ** -0.5)
        log_dt = (lambda *s: torch.randn(*s, dtype=torch.bfloat16) * 0.4)(P) * 0.3 - 2.0
        Dskip = (lambda *s: torch.randn(*s, dtype=torch.bfloat16) * 0.2)(D)
        return {
            "x": _w((lambda *s: torch.randn(*s, dtype=torch.bfloat16) * 0.05)(B, S, D)),
            "Lambda_re": _w(Lambda_re),
            "Lambda_im": _w(Lambda_im),
            "B_re": _w(B_re),
            "B_im": _w(B_im),
            "C_re": _w(C_re),
            "C_im": _w(C_im),
            "log_dt": _w(log_dt),
            "Dskip": _w(Dskip),
        }
    _A_in = _A_setup()

    def _B_setup():
        B, S, D, F = 1, 2048, 512, 1376
        return {
            "x": _w((lambda *s: torch.randn(*s, dtype=torch.bfloat16) * 0.05)(B, S, D)),
            "w1": _w((lambda *s: torch.randn(*s, dtype=torch.bfloat16) * 0.4)(S, F) * (S ** -0.5)),
            "b1": _w((lambda *s: torch.randn(*s, dtype=torch.bfloat16) * 3.2)(F) * 0.02),
            "w2": _w((lambda *s: torch.randn(*s, dtype=torch.bfloat16) * 0.8)(F, S) * (F ** -0.5)),
            "b2": _w((lambda *s: torch.randn(*s, dtype=torch.bfloat16) * 1.6)(S) * 0.02),
        }
    _B_in = _B_setup()

    return {
        "A_x": _A_in["x"],
        "A_Lambda_re": _A_in["Lambda_re"],
        "A_Lambda_im": _A_in["Lambda_im"],
        "A_B_re": _A_in["B_re"],
        "A_B_im": _A_in["B_im"],
        "A_C_re": _A_in["C_re"],
        "A_C_im": _A_in["C_im"],
        "A_log_dt": _A_in["log_dt"],
        "A_Dskip": _A_in["Dskip"],
        "B_x": _B_in["x"],
        "B_w1": _B_in["w1"],
        "B_b1": _B_in["b1"],
        "B_w2": _B_in["w2"],
        "B_b2": _B_in["b2"],
    }

def reference(A_x, A_Lambda_re, A_Lambda_im, A_B_re, A_B_im, A_C_re, A_C_im, A_log_dt, A_Dskip, B_x, B_w1, B_b1, B_w2, B_b2):
    def _A_ref(x, Lambda_re, Lambda_im, B_re, B_im, C_re, C_im, log_dt, Dskip):
        Bsz, L, H = x.shape
        Lam = Lambda_re + 1j * Lambda_im
        Bmat = B_re + 1j * B_im
        Cmat = C_re + 1j * C_im
        dt = torch.exp(log_dt)
        Lam_bar = torch.exp(dt * Lam)
        B_bar = ((Lam_bar - 1.0) / Lam)[:, None] * Bmat
        Bu = torch.einsum("bld,pd->blp", x + 0j, B_bar)
        h = torch.zeros_like(Bu[:, 0, :])
        hs = []
        for t in range(L):
            h = Lam_bar[None, :] * h + Bu[:, t, :]
            hs.append(h)
        hseq = torch.stack(hs, 1)
        y = 2.0 * torch.einsum("blp,dp->bld", hseq, Cmat).real + x * Dskip[None, None, :]
        return y

    def _B_ref(x, w1, b1, w2, b2):
        B, S, D = x.shape
        h = _layernorm(x, axis=-1)
        u = torch.einsum("bsd,sf->bdf", h, w1) + b1
        u = _gelu(u)
        y = torch.einsum("bdf,fs->bds", u, w2) + b2
        return (lambda x, *d: x.permute(*d))(y, 0, 2, 1)

    x = A_x
    xn = _layernorm(x, axis=-1)
    s = _A_ref(xn, A_Lambda_re, A_Lambda_im, A_B_re, A_B_im, A_C_re, A_C_im, A_log_dt, A_Dskip)
    g = _silu(_B_ref(xn, B_w1, B_b1, B_w2, B_b2))
    return x + s * g
```

```asm
; @launch grid=(256,1,1) block=(512,1,1) lds=155648
.amdgcn_target "amdgcn-amd-amdhsa--gfx950"
.text
.globl recurrent_scan__ssm_conv_s5__mixer_token_mlp__prompt_kernel
.p2align 8
.type recurrent_scan__ssm_conv_s5__mixer_token_mlp__prompt_kernel,@function
recurrent_scan__ssm_conv_s5__mixer_token_mlp__prompt_kernel:
    s_cmp_ge_u32 s2, 256
    s_cbranch_scc1 k_end
    s_load_dwordx16 s[68:83], s[0:1], 0
    s_load_dwordx2 s[16:17], s[0:1], 128
    s_load_dwordx16 s[84:99], s[0:1], 64
    v_lshrrev_b32 v2, 6, v0
    v_and_b32 v1, 63, v0
    v_readfirstlane_b32 s3, v2
    s_and_b32 s18, s2, 7
    s_lshr_b32 s19, s2, 3
    s_lshr_b32 s12, s18, 1
    s_lshl_b32 s12, s12, 2
    s_and_b32 s22, s19, 3
    s_add_u32 s12, s12, s22
    s_and_b32 s13, s18, 1
    s_lshl_b32 s13, s13, 3
    s_lshr_b32 s22, s19, 2
    s_add_u32 s13, s13, s22
    s_mul_i32 s20, s18, 22
    s_add_u32 s20, s20, s19
    s_and_b32 s48, s20, 7
    s_lshr_b32 s49, s20, 3
    s_cmp_lt_u32 s19, 22
    s_cselect_b32 s50, -1, 0
    s_and_b32 s49, s49, s50
    s_and_b32 s51, s19, 7
    s_lshr_b32 s53, s19, 3
    s_lshl_b32 s52, s18, 2
    s_add_u32 s52, s52, s53
    v_and_b32 v3, 31, v1
    s_cmp_ge_u32 s3, 4
    s_cbranch_scc1 loader
    s_lshl_b32 s20, s12, 7
    s_lshl_b32 s21, s13, 3
    s_add_u32 s20, s20, s21
    s_lshl_b32 s21, s3, 1
    s_add_u32 s20, s20, s21
    s_lshl_b32 s37, s20, 10
    v_lshlrev_b32 v13, 4, v1
    s_lshl_b32 s22, s13, 6
    v_lshl_add_u32 v4, v3, 1, s22
    v_mov_b32 v14, 0
    s_waitcnt lgkmcnt(0)
    s_mov_b32 s4, s68
    s_mov_b32 s5, s69
    s_mov_b32 s6, 2097152
    s_mov_b32 s7, 0x00020000
    s_mov_b32 s28, s84
    s_mov_b32 s29, s85
    s_mov_b32 s30, 1024
    s_mov_b32 s31, 0x00020000
    buffer_load_dwordx4 v[48:51], v13, s[4:7], s37 offen
    buffer_load_dwordx4 v[52:55], v13, s[4:7], s37 offen offset:1024
    s_add_u32 s32, s16, 14680064
    s_addc_u32 s33, s17, 0
    s_mov_b32 s34, 196608
    s_mov_b32 s35, 0x00020000
    buffer_load_dwordx4 v[56:59], v13, s[28:31], 0 offen
    buffer_load_dword v244, v14, s[32:35], 0 offen sc1
    s_mov_b32 s56, s70
    s_mov_b32 s57, s71
    s_mov_b32 s58, 1024
    s_mov_b32 s59, 0x00020000
    s_mov_b32 s60, s72
    s_mov_b32 s61, s73
    s_mov_b32 s62, 1024
    s_mov_b32 s63, 0x00020000
    s_mov_b32 s64, s82
    s_mov_b32 s65, s83
    s_mov_b32 s66, 1024
    s_mov_b32 s67, 0x00020000
    buffer_load_ushort v200, v4, s[56:59], 0 offen
    buffer_load_ushort v201, v4, s[60:63], 0 offen
    buffer_load_ushort v202, v4, s[64:67], 0 offen
    s_mov_b32 s24, s16
    s_mov_b32 s25, s17
    s_mov_b32 s26, 4194304
    s_mov_b32 s27, 0x00020000
    v_bfe_u32 v5, v1, 2, 1
    v_lshlrev_b32 v5, 4, v5
    v_bfe_u32 v6, v1, 3, 2
    v_lshl_add_u32 v5, v6, 2, v5
    v_and_b32 v6, 3, v1
    v_add_u32 v5, v5, v6
    v_lshrrev_b32 v7, 5, v1
    s_lshl_b32 s20, s3, 1
    v_or_b32 v8, s20, v7
    v_bfe_u32 v9, v5, 1, 3
    v_xor_b32 v9, v9, v8
    v_bfe_u32 v10, v3, 1, 3
    v_xor_b32 v245, v10, v7
    v_xor_b32 v10, v10, v8
    s_lshl_b32 s21, s3, 12
    v_lshl_add_u32 v11, v5, 7, s21
    v_lshlrev_b32 v12, 7, v3
    v_lshl_add_u32 v245, v245, 4, v12
    v_add_u32 v12, 16384, v12
    v_xor_b32 v2, 0, v9
    v_lshl_add_u32 v180, v2, 4, v11
    v_xor_b32 v2, 0, v10
    v_lshl_add_u32 v184, v2, 4, v12
    v_xor_b32 v2, 2, v9
    v_lshl_add_u32 v181, v2, 4, v11
    v_xor_b32 v2, 2, v10
    v_lshl_add_u32 v185, v2, 4, v12
    v_xor_b32 v2, 4, v9
    v_lshl_add_u32 v182, v2, 4, v11
    v_xor_b32 v2, 4, v10
    v_lshl_add_u32 v186, v2, 4, v12
    v_xor_b32 v2, 6, v9
    v_lshl_add_u32 v183, v2, 4, v11
    v_xor_b32 v2, 6, v10
    v_lshl_add_u32 v187, v2, 4, v12
    v_mov_b32 v15, 0
    v_mov_b32 v16, 0
    v_mov_b32 v17, 0
    v_mov_b32 v18, 0
    v_mov_b32 v19, 0
    v_mov_b32 v20, 0
    v_mov_b32 v21, 0
    v_mov_b32 v22, 0
    v_mov_b32 v23, 0
    v_mov_b32 v24, 0
    v_mov_b32 v25, 0
    v_mov_b32 v26, 0
    v_mov_b32 v27, 0
    v_mov_b32 v28, 0
    v_mov_b32 v29, 0
    v_mov_b32 v30, 0
    v_mov_b32 v31, 0
    v_mov_b32 v32, 0
    v_mov_b32 v33, 0
    v_mov_b32 v34, 0
    v_mov_b32 v35, 0
    v_mov_b32 v36, 0
    v_mov_b32 v37, 0
    v_mov_b32 v38, 0
    v_mov_b32 v39, 0
    v_mov_b32 v40, 0
    v_mov_b32 v41, 0
    v_mov_b32 v42, 0
    v_mov_b32 v43, 0
    v_mov_b32 v44, 0
    v_mov_b32 v45, 0
    v_mov_b32 v46, 0
    v_mov_b32 v47, 0
    v_mov_b32 v196, 0
    v_mov_b32 v197, 0
    v_mov_b32 v80, 0
    v_mov_b32 v81, 0
    v_mov_b32 v82, 0
    v_mov_b32 v83, 0
    v_mov_b32 v198, 0x3f803f80
    v_lshlrev_b32 v2, 3, v0
    v_cmp_gt_u32 vcc, 1792, v2
    s_nop 1
    v_cndmask_b32 v2, 0, v2, vcc
    ds_write_b64 v2, v[14:15] offset:1024

    s_and_b32 s54, s3, 1
    s_lshr_b32 s55, s3, 1
    v_lshlrev_b32 v6, 10, v7
    v_bfe_u32 v9, v1, 2, 2
    v_lshl_add_u32 v6, v9, 7, v6
    v_bfe_u32 v9, v1, 4, 1
    v_lshlrev_b32 v9, 1, v9
    v_bfe_u32 v10, v1, 1, 1
    v_add_u32 v9, v9, v10
    v_bfe_u32 v10, v1, 3, 1
    v_lshlrev_b32 v10, 2, v10
    v_xor_b32 v9, v9, v10
    v_lshl_add_u32 v6, v9, 4, v6
    v_and_b32 v9, 1, v1
    v_lshl_add_u32 v6, v9, 3, v6
    s_lshl_b32 s20, s54, 6
    s_lshl_b32 s21, s55, 6
    v_xor_b32 v176, s20, v6
    v_xor_b32 v178, s21, v6
    v_add_u32 v176, 8192, v176
    v_add_u32 v178, 16384, v178
    v_add_u32 v177, 0x10000, v176
    v_add_u32 v179, 0x10000, v178
    s_lshl_b32 s20, s54, 12
    s_add_u32 s20, s20, 8192
    v_add_u32 v245, s20, v245
    v_lshrrev_b32 v60, 3, v1
    v_lshlrev_b32 v60, 18, v60
    v_and_b32 v9, 7, v1
    v_lshl_add_u32 v60, v9, 4, v60
    s_lshr_b32 s23, s37, 3
    s_waitcnt vmcnt(5)
    v_dot2c_f32_bf16 v80, v48, v198
    v_dot2c_f32_bf16 v81, v48, v48
    v_dot2c_f32_bf16 v82, v52, v198
    v_dot2c_f32_bf16 v83, v52, v52
    v_dot2c_f32_bf16 v80, v49, v198
    v_dot2c_f32_bf16 v81, v49, v49
    v_dot2c_f32_bf16 v82, v53, v198
    v_dot2c_f32_bf16 v83, v53, v53
    v_dot2c_f32_bf16 v80, v50, v198
    v_dot2c_f32_bf16 v81, v50, v50
    v_dot2c_f32_bf16 v82, v54, v198
    v_dot2c_f32_bf16 v83, v54, v54
    v_dot2c_f32_bf16 v80, v51, v198
    v_dot2c_f32_bf16 v81, v51, v51
    v_dot2c_f32_bf16 v82, v55, v198
    v_dot2c_f32_bf16 v83, v55, v55
    v_lshlrev_b32 v64, 16, v48
    v_and_b32 v65, 0xffff0000, v48
    v_lshlrev_b32 v66, 16, v49
    v_and_b32 v67, 0xffff0000, v49
    v_lshlrev_b32 v68, 16, v50
    v_and_b32 v69, 0xffff0000, v50
    v_lshlrev_b32 v70, 16, v51
    v_and_b32 v71, 0xffff0000, v51
    v_lshlrev_b32 v72, 16, v52
    v_and_b32 v73, 0xffff0000, v52
    v_lshlrev_b32 v74, 16, v53
    v_and_b32 v75, 0xffff0000, v53
    v_lshlrev_b32 v76, 16, v54
    v_and_b32 v77, 0xffff0000, v54
    v_lshlrev_b32 v78, 16, v55
    v_and_b32 v79, 0xffff0000, v55
    v_add_f32_dpp v80, v80, v80 quad_perm:[1,0,3,2] row_mask:0xf bank_mask:0xf
    v_add_f32_dpp v81, v81, v81 quad_perm:[1,0,3,2] row_mask:0xf bank_mask:0xf
    v_add_f32_dpp v82, v82, v82 quad_perm:[1,0,3,2] row_mask:0xf bank_mask:0xf
    v_add_f32_dpp v83, v83, v83 quad_perm:[1,0,3,2] row_mask:0xf bank_mask:0xf
    v_add_f32_dpp v80, v80, v80 quad_perm:[2,3,0,1] row_mask:0xf bank_mask:0xf
    v_add_f32_dpp v81, v81, v81 quad_perm:[2,3,0,1] row_mask:0xf bank_mask:0xf
    v_add_f32_dpp v82, v82, v82 quad_perm:[2,3,0,1] row_mask:0xf bank_mask:0xf
    v_add_f32_dpp v83, v83, v83 quad_perm:[2,3,0,1] row_mask:0xf bank_mask:0xf
    v_add_f32_dpp v80, v80, v80 row_half_mirror row_mask:0xf bank_mask:0xf
    v_add_f32_dpp v81, v81, v81 row_half_mirror row_mask:0xf bank_mask:0xf
    v_add_f32_dpp v82, v82, v82 row_half_mirror row_mask:0xf bank_mask:0xf
    v_add_f32_dpp v83, v83, v83 row_half_mirror row_mask:0xf bank_mask:0xf
    v_add_f32_dpp v80, v80, v80 row_mirror row_mask:0xf bank_mask:0xf
    v_add_f32_dpp v81, v81, v81 row_mirror row_mask:0xf bank_mask:0xf
    v_add_f32_dpp v82, v82, v82 row_mirror row_mask:0xf bank_mask:0xf
    v_add_f32_dpp v83, v83, v83 row_mirror row_mask:0xf bank_mask:0xf
    v_mov_b32 v84, v80
    v_mov_b32 v85, v81
    v_mov_b32 v86, v82
    v_mov_b32 v87, v83
    s_nop 1
    v_permlane16_swap_b32 v80, v84
    v_permlane16_swap_b32 v81, v85
    v_permlane16_swap_b32 v82, v86
    v_permlane16_swap_b32 v83, v87
    s_nop 1
    v_add_f32 v80, v80, v84
    v_add_f32 v81, v81, v85
    v_add_f32 v82, v82, v86
    v_add_f32 v83, v83, v87
    v_mov_b32 v84, v80
    v_mov_b32 v85, v81
    v_mov_b32 v86, v82
    v_mov_b32 v87, v83
    s_nop 1
    v_permlane32_swap_b32 v80, v84
    v_permlane32_swap_b32 v81, v85
    v_permlane32_swap_b32 v82, v86
    v_permlane32_swap_b32 v83, v87
    s_nop 1
    v_add_f32 v80, v80, v84
    v_add_f32 v81, v81, v85
    v_add_f32 v82, v82, v86
    v_add_f32 v83, v83, v87
    v_mul_f32 v80, 0x3b000000, v80
    v_mul_f32 v81, 0x3b000000, v81
    v_fma_f32 v81, -v80, v80, v81
    v_max_f32 v81, 0, v81
    v_cvt_pk_bf16_f32 v88, v80, v81
    v_and_b32 v81, 0xffff0000, v88
    v_lshlrev_b32 v88, 16, v88
    v_add_f32 v81, 0x3727c5ac, v81
    v_cvt_pk_bf16_f32 v81, v81, v81
    v_lshlrev_b32 v81, 16, v81
    v_sqrt_f32 v81, v81
    s_nop 0
    v_cvt_pk_bf16_f32 v81, v81, v81
    v_lshlrev_b32 v81, 16, v81
    v_rcp_f32 v89, v81
    s_nop 0
    v_mul_f32 v82, 0x3b000000, v82
    v_mul_f32 v83, 0x3b000000, v83
    v_fma_f32 v83, -v82, v82, v83
    v_max_f32 v83, 0, v83
    v_cvt_pk_bf16_f32 v90, v82, v83
    v_and_b32 v83, 0xffff0000, v90
    v_lshlrev_b32 v90, 16, v90
    v_add_f32 v83, 0x3727c5ac, v83
    v_cvt_pk_bf16_f32 v83, v83, v83
    v_lshlrev_b32 v83, 16, v83
    v_sqrt_f32 v83, v83
    s_nop 0
    v_cvt_pk_bf16_f32 v83, v83, v83
    v_lshlrev_b32 v83, 16, v83
    v_rcp_f32 v91, v83
    s_nop 0
    s_lshr_b32 s20, s37, 7
    s_add_u32 s20, s20, 32768
    v_lshrrev_b32 v84, 16, v88
    v_or_b32 v84, v84, v90
    v_mov_b32 v85, v89
    v_mov_b32 v86, v91
    s_waitcnt vmcnt(0)
    v_add_u32 v244, 0x9e3779b9, v244
    s_mov_b64 exec, 1
    v_mov_b32 v87, v244
    buffer_store_dwordx4 v[84:87], v14, s[32:35], s20 offen sc1
    s_mov_b64 exec, -1
    v_pk_add_f32 v[64:65], v[64:65], v[88:89] op_sel:[0,0] op_sel_hi:[1,0] neg_lo:[0,1] neg_hi:[0,1]
    v_pk_add_f32 v[66:67], v[66:67], v[88:89] op_sel:[0,0] op_sel_hi:[1,0] neg_lo:[0,1] neg_hi:[0,1]
    v_pk_add_f32 v[68:69], v[68:69], v[88:89] op_sel:[0,0] op_sel_hi:[1,0] neg_lo:[0,1] neg_hi:[0,1]
    v_pk_add_f32 v[70:71], v[70:71], v[88:89] op_sel:[0,0] op_sel_hi:[1,0] neg_lo:[0,1] neg_hi:[0,1]
    v_cvt_pk_bf16_f32 v84, v64, v65
    v_lshlrev_b32 v64, 16, v84
    v_and_b32 v65, 0xffff0000, v84
    v_cvt_pk_bf16_f32 v85, v66, v67
    v_lshlrev_b32 v66, 16, v85
    v_and_b32 v67, 0xffff0000, v85
    v_cvt_pk_bf16_f32 v86, v68, v69
    v_lshlrev_b32 v68, 16, v86
    v_and_b32 v69, 0xffff0000, v86
    v_cvt_pk_bf16_f32 v87, v70, v71
    v_lshlrev_b32 v70, 16, v87
    v_and_b32 v71, 0xffff0000, v87
    v_pk_mul_f32 v[64:65], v[64:65], v[88:89] op_sel:[0,1] op_sel_hi:[1,1]
    v_pk_mul_f32 v[66:67], v[66:67], v[88:89] op_sel:[0,1] op_sel_hi:[1,1]
    v_pk_mul_f32 v[68:69], v[68:69], v[88:89] op_sel:[0,1] op_sel_hi:[1,1]
    v_pk_mul_f32 v[70:71], v[70:71], v[88:89] op_sel:[0,1] op_sel_hi:[1,1]
    v_cvt_pk_bf16_f32 v92, v64, v65
    v_cvt_pk_bf16_f32 v93, v66, v67
    v_cvt_pk_bf16_f32 v94, v68, v69
    v_cvt_pk_bf16_f32 v95, v70, v71
    v_pk_add_f32 v[72:73], v[72:73], v[90:91] op_sel:[0,0] op_sel_hi:[1,0] neg_lo:[0,1] neg_hi:[0,1]
    v_pk_add_f32 v[74:75], v[74:75], v[90:91] op_sel:[0,0] op_sel_hi:[1,0] neg_lo:[0,1] neg_hi:[0,1]
    v_pk_add_f32 v[76:77], v[76:77], v[90:91] op_sel:[0,0] op_sel_hi:[1,0] neg_lo:[0,1] neg_hi:[0,1]
    v_pk_add_f32 v[78:79], v[78:79], v[90:91] op_sel:[0,0] op_sel_hi:[1,0] neg_lo:[0,1] neg_hi:[0,1]
    v_cvt_pk_bf16_f32 v84, v72, v73
    v_lshlrev_b32 v72, 16, v84
    v_and_b32 v73, 0xffff0000, v84
    v_cvt_pk_bf16_f32 v85, v74, v75
    v_lshlrev_b32 v74, 16, v85
    v_and_b32 v75, 0xffff0000, v85
    v_cvt_pk_bf16_f32 v86, v76, v77
    v_lshlrev_b32 v76, 16, v86
    v_and_b32 v77, 0xffff0000, v86
    v_cvt_pk_bf16_f32 v87, v78, v79
    v_lshlrev_b32 v78, 16, v87
    v_and_b32 v79, 0xffff0000, v87
    v_pk_mul_f32 v[72:73], v[72:73], v[90:91] op_sel:[0,1] op_sel_hi:[1,1]
    v_pk_mul_f32 v[74:75], v[74:75], v[90:91] op_sel:[0,1] op_sel_hi:[1,1]
    v_pk_mul_f32 v[76:77], v[76:77], v[90:91] op_sel:[0,1] op_sel_hi:[1,1]
    v_pk_mul_f32 v[78:79], v[78:79], v[90:91] op_sel:[0,1] op_sel_hi:[1,1]
    v_cvt_pk_bf16_f32 v96, v72, v73
    v_cvt_pk_bf16_f32 v97, v74, v75
    v_cvt_pk_bf16_f32 v98, v76, v77
    v_cvt_pk_bf16_f32 v99, v78, v79
    v_mov_b32 v80, 0
    v_mov_b32 v81, 0
    v_mov_b32 v82, 0
    v_mov_b32 v83, 0
    v_dot2c_f32_bf16 v80, v92, v198
    v_dot2c_f32_bf16 v81, v92, v92
    v_dot2c_f32_bf16 v82, v96, v198
    v_dot2c_f32_bf16 v83, v96, v96
    v_dot2c_f32_bf16 v80, v93, v198
    v_dot2c_f32_bf16 v81, v93, v93
    v_dot2c_f32_bf16 v82, v97, v198
    v_dot2c_f32_bf16 v83, v97, v97
    v_dot2c_f32_bf16 v80, v94, v198
    v_dot2c_f32_bf16 v81, v94, v94
    v_dot2c_f32_bf16 v82, v98, v198
    v_dot2c_f32_bf16 v83, v98, v98
    v_dot2c_f32_bf16 v80, v95, v198
    v_dot2c_f32_bf16 v81, v95, v95
    v_dot2c_f32_bf16 v82, v99, v198
    v_dot2c_f32_bf16 v83, v99, v99
    v_lshlrev_b32 v64, 16, v92
    v_and_b32 v65, 0xffff0000, v92
    v_lshlrev_b32 v66, 16, v93
    v_and_b32 v67, 0xffff0000, v93
    v_lshlrev_b32 v68, 16, v94
    v_and_b32 v69, 0xffff0000, v94
    v_lshlrev_b32 v70, 16, v95
    v_and_b32 v71, 0xffff0000, v95
    v_lshlrev_b32 v72, 16, v96
    v_and_b32 v73, 0xffff0000, v96
    v_lshlrev_b32 v74, 16, v97
    v_and_b32 v75, 0xffff0000, v97
    v_lshlrev_b32 v76, 16, v98
    v_and_b32 v77, 0xffff0000, v98
    v_lshlrev_b32 v78, 16, v99
    v_and_b32 v79, 0xffff0000, v99
    v_add_f32_dpp v80, v80, v80 quad_perm:[1,0,3,2] row_mask:0xf bank_mask:0xf
    v_add_f32_dpp v81, v81, v81 quad_perm:[1,0,3,2] row_mask:0xf bank_mask:0xf
    v_add_f32_dpp v82, v82, v82 quad_perm:[1,0,3,2] row_mask:0xf bank_mask:0xf
    v_add_f32_dpp v83, v83, v83 quad_perm:[1,0,3,2] row_mask:0xf bank_mask:0xf
    v_add_f32_dpp v80, v80, v80 quad_perm:[2,3,0,1] row_mask:0xf bank_mask:0xf
    v_add_f32_dpp v81, v81, v81 quad_perm:[2,3,0,1] row_mask:0xf bank_mask:0xf
    v_add_f32_dpp v82, v82, v82 quad_perm:[2,3,0,1] row_mask:0xf bank_mask:0xf
    v_add_f32_dpp v83, v83, v83 quad_perm:[2,3,0,1] row_mask:0xf bank_mask:0xf
    v_add_f32_dpp v80, v80, v80 row_half_mirror row_mask:0xf bank_mask:0xf
    v_add_f32_dpp v81, v81, v81 row_half_mirror row_mask:0xf bank_mask:0xf
    v_add_f32_dpp v82, v82, v82 row_half_mirror row_mask:0xf bank_mask:0xf
    v_add_f32_dpp v83, v83, v83 row_half_mirror row_mask:0xf bank_mask:0xf
    v_add_f32_dpp v80, v80, v80 row_mirror row_mask:0xf bank_mask:0xf
    v_add_f32_dpp v81, v81, v81 row_mirror row_mask:0xf bank_mask:0xf
    v_add_f32_dpp v82, v82, v82 row_mirror row_mask:0xf bank_mask:0xf
    v_add_f32_dpp v83, v83, v83 row_mirror row_mask:0xf bank_mask:0xf
    v_mov_b32 v84, v80
    v_mov_b32 v85, v81
    v_mov_b32 v86, v82
    v_mov_b32 v87, v83
    s_nop 1
    v_permlane16_swap_b32 v80, v84
    v_permlane16_swap_b32 v81, v85
    v_permlane16_swap_b32 v82, v86
    v_permlane16_swap_b32 v83, v87
    s_nop 1
    v_add_f32 v80, v80, v84
    v_add_f32 v81, v81, v85
    v_add_f32 v82, v82, v86
    v_add_f32 v83, v83, v87
    v_mov_b32 v84, v80
    v_mov_b32 v85, v81
    v_mov_b32 v86, v82
    v_mov_b32 v87, v83
    s_nop 1
    v_permlane32_swap_b32 v80, v84
    v_permlane32_swap_b32 v81, v85
    v_permlane32_swap_b32 v82, v86
    v_permlane32_swap_b32 v83, v87
    s_nop 1
    v_add_f32 v80, v80, v84
    v_add_f32 v81, v81, v85
    v_add_f32 v82, v82, v86
    v_add_f32 v83, v83, v87
    v_mul_f32 v80, 0x3b000000, v80
    v_mul_f32 v81, 0x3b000000, v81
    v_fma_f32 v81, -v80, v80, v81
    v_max_f32 v81, 0, v81
    v_cvt_pk_bf16_f32 v88, v80, v81
    v_and_b32 v81, 0xffff0000, v88
    v_lshlrev_b32 v88, 16, v88
    v_add_f32 v81, 0x3727c5ac, v81
    v_cvt_pk_bf16_f32 v81, v81, v81
    v_lshlrev_b32 v81, 16, v81
    v_sqrt_f32 v81, v81
    s_nop 0
    v_cvt_pk_bf16_f32 v81, v81, v81
    v_lshlrev_b32 v81, 16, v81
    v_rcp_f32 v89, v81
    s_nop 0
    v_mul_f32 v82, 0x3b000000, v82
    v_mul_f32 v83, 0x3b000000, v83
    v_fma_f32 v83, -v82, v82, v83
    v_max_f32 v83, 0, v83
    v_cvt_pk_bf16_f32 v90, v82, v83
    v_and_b32 v83, 0xffff0000, v90
    v_lshlrev_b32 v90, 16, v90
    v_add_f32 v83, 0x3727c5ac, v83
    v_cvt_pk_bf16_f32 v83, v83, v83
    v_lshlrev_b32 v83, 16, v83
    v_sqrt_f32 v83, v83
    s_nop 0
    v_cvt_pk_bf16_f32 v83, v83, v83
    v_lshlrev_b32 v83, 16, v83
    v_rcp_f32 v91, v83
    s_nop 0
    v_pk_add_f32 v[64:65], v[64:65], v[88:89] op_sel:[0,0] op_sel_hi:[1,0] neg_lo:[0,1] neg_hi:[0,1]
    v_pk_add_f32 v[66:67], v[66:67], v[88:89] op_sel:[0,0] op_sel_hi:[1,0] neg_lo:[0,1] neg_hi:[0,1]
    v_pk_add_f32 v[68:69], v[68:69], v[88:89] op_sel:[0,0] op_sel_hi:[1,0] neg_lo:[0,1] neg_hi:[0,1]
    v_pk_add_f32 v[70:71], v[70:71], v[88:89] op_sel:[0,0] op_sel_hi:[1,0] neg_lo:[0,1] neg_hi:[0,1]
    v_cvt_pk_bf16_f32 v84, v64, v65
    v_lshlrev_b32 v64, 16, v84
    v_and_b32 v65, 0xffff0000, v84
    v_cvt_pk_bf16_f32 v85, v66, v67
    v_lshlrev_b32 v66, 16, v85
    v_and_b32 v67, 0xffff0000, v85
    v_cvt_pk_bf16_f32 v86, v68, v69
    v_lshlrev_b32 v68, 16, v86
    v_and_b32 v69, 0xffff0000, v86
    v_cvt_pk_bf16_f32 v87, v70, v71
    v_lshlrev_b32 v70, 16, v87
    v_and_b32 v71, 0xffff0000, v87
    v_pk_mul_f32 v[64:65], v[64:65], v[88:89] op_sel:[0,1] op_sel_hi:[1,1]
    v_pk_mul_f32 v[66:67], v[66:67], v[88:89] op_sel:[0,1] op_sel_hi:[1,1]
    v_pk_mul_f32 v[68:69], v[68:69], v[88:89] op_sel:[0,1] op_sel_hi:[1,1]
    v_pk_mul_f32 v[70:71], v[70:71], v[88:89] op_sel:[0,1] op_sel_hi:[1,1]
    v_cvt_pk_bf16_f32 v100, v64, v65
    v_cvt_pk_bf16_f32 v101, v66, v67
    v_cvt_pk_bf16_f32 v102, v68, v69
    v_cvt_pk_bf16_f32 v103, v70, v71
    buffer_store_dwordx4 v[100:103], v60, s[24:27], s23 offen offset:0 sc1
    v_pk_add_f32 v[72:73], v[72:73], v[90:91] op_sel:[0,0] op_sel_hi:[1,0] neg_lo:[0,1] neg_hi:[0,1]
    v_pk_add_f32 v[74:75], v[74:75], v[90:91] op_sel:[0,0] op_sel_hi:[1,0] neg_lo:[0,1] neg_hi:[0,1]
    v_pk_add_f32 v[76:77], v[76:77], v[90:91] op_sel:[0,0] op_sel_hi:[1,0] neg_lo:[0,1] neg_hi:[0,1]
    v_pk_add_f32 v[78:79], v[78:79], v[90:91] op_sel:[0,0] op_sel_hi:[1,0] neg_lo:[0,1] neg_hi:[0,1]
    v_cvt_pk_bf16_f32 v84, v72, v73
    v_lshlrev_b32 v72, 16, v84
    v_and_b32 v73, 0xffff0000, v84
    v_cvt_pk_bf16_f32 v85, v74, v75
    v_lshlrev_b32 v74, 16, v85
    v_and_b32 v75, 0xffff0000, v85
    v_cvt_pk_bf16_f32 v86, v76, v77
    v_lshlrev_b32 v76, 16, v86
    v_and_b32 v77, 0xffff0000, v86
    v_cvt_pk_bf16_f32 v87, v78, v79
    v_lshlrev_b32 v78, 16, v87
    v_and_b32 v79, 0xffff0000, v87
    v_pk_mul_f32 v[72:73], v[72:73], v[90:91] op_sel:[0,1] op_sel_hi:[1,1]
    v_pk_mul_f32 v[74:75], v[74:75], v[90:91] op_sel:[0,1] op_sel_hi:[1,1]
    v_pk_mul_f32 v[76:77], v[76:77], v[90:91] op_sel:[0,1] op_sel_hi:[1,1]
    v_pk_mul_f32 v[78:79], v[78:79], v[90:91] op_sel:[0,1] op_sel_hi:[1,1]
    v_cvt_pk_bf16_f32 v104, v72, v73
    v_cvt_pk_bf16_f32 v105, v74, v75
    v_cvt_pk_bf16_f32 v106, v76, v77
    v_cvt_pk_bf16_f32 v107, v78, v79
    buffer_store_dwordx4 v[104:107], v60, s[24:27], s23 offen offset:128 sc1
    v_lshlrev_b32 v108, 16, v56
    v_and_b32 v109, 0xffff0000, v56
    v_lshlrev_b32 v110, 16, v57
    v_and_b32 v111, 0xffff0000, v57
    v_lshlrev_b32 v112, 16, v58
    v_and_b32 v113, 0xffff0000, v58
    v_lshlrev_b32 v114, 16, v59
    v_and_b32 v115, 0xffff0000, v59
    v_lshlrev_b32 v64, 16, v92
    v_and_b32 v65, 0xffff0000, v92
    v_lshlrev_b32 v66, 16, v93
    v_and_b32 v67, 0xffff0000, v93
    v_lshlrev_b32 v68, 16, v94
    v_and_b32 v69, 0xffff0000, v94
    v_lshlrev_b32 v70, 16, v95
    v_and_b32 v71, 0xffff0000, v95
    v_pk_mul_f32 v[64:65], v[64:65], v[108:109]
    v_pk_mul_f32 v[66:67], v[66:67], v[110:111]
    v_pk_mul_f32 v[68:69], v[68:69], v[112:113]
    v_pk_mul_f32 v[70:71], v[70:71], v[114:115]
    v_cvt_pk_bf16_f32 v144, v64, v65
    v_cvt_pk_bf16_f32 v145, v66, v67
    v_cvt_pk_bf16_f32 v146, v68, v69
    v_cvt_pk_bf16_f32 v147, v70, v71
    v_lshlrev_b32 v64, 16, v96
    v_and_b32 v65, 0xffff0000, v96
    v_lshlrev_b32 v66, 16, v97
    v_and_b32 v67, 0xffff0000, v97
    v_lshlrev_b32 v68, 16, v98
    v_and_b32 v69, 0xffff0000, v98
    v_lshlrev_b32 v70, 16, v99
    v_and_b32 v71, 0xffff0000, v99
    v_pk_mul_f32 v[64:65], v[64:65], v[108:109]
    v_pk_mul_f32 v[66:67], v[66:67], v[110:111]
    v_pk_mul_f32 v[68:69], v[68:69], v[112:113]
    v_pk_mul_f32 v[70:71], v[70:71], v[114:115]
    v_cvt_pk_bf16_f32 v148, v64, v65
    v_cvt_pk_bf16_f32 v149, v66, v67
    v_cvt_pk_bf16_f32 v150, v68, v69
    v_cvt_pk_bf16_f32 v151, v70, v71
    v_lshlrev_b32 v200, 16, v200
    v_lshlrev_b32 v201, 16, v201
    v_lshlrev_b32 v202, 16, v202
    v_mul_f32 v202, 0x3fb8aa3b, v202
    v_exp_f32 v202, v202
    s_nop 0
    v_cvt_pk_bf16_f32 v202, v202, v202
    v_lshlrev_b32 v202, 16, v202
    v_mul_f32 v203, v202, v201
    v_mul_f32 v202, v202, v200
    v_mul_f32 v203, 0x3e22f983, v203
    v_mul_f32 v202, 0x3fb8aa3b, v202
    v_mul_f32 v204, 1.0, v202
    v_mul_f32 v2, 1.0, v203
    v_exp_f32 v204, v204
    v_fract_f32 v2, v2
    v_sin_f32 v205, v2
    v_cos_f32 v2, v2
    s_nop 0
    v_mul_f32 v205, v205, v204
    v_mul_f32 v204, v2, v204
    v_mul_f32 v206, 0x41800000, v202
    v_mul_f32 v2, 0x41800000, v203
    v_exp_f32 v206, v206
    v_fract_f32 v2, v2
    v_sin_f32 v207, v2
    v_cos_f32 v2, v2
    s_nop 0
    v_mul_f32 v207, v207, v206
    v_mul_f32 v206, v2, v206
    v_mov_b32 v96, 0
    v_mov_b32 v97, 0
    v_mov_b32 v98, 0
    v_mov_b32 v99, 0
    v_mov_b32 v100, 0
    v_mov_b32 v101, 0
    v_mov_b32 v102, 0
    v_mov_b32 v103, 0
    v_mov_b32 v104, 0
    v_mov_b32 v105, 0
    v_mov_b32 v106, 0
    v_mov_b32 v107, 0
    v_mov_b32 v108, 0
    v_mov_b32 v109, 0
    v_mov_b32 v110, 0
    v_mov_b32 v111, 0
    v_mov_b32 v112, 0
    v_mov_b32 v113, 0
    v_mov_b32 v114, 0
    v_mov_b32 v115, 0
    v_mov_b32 v116, 0
    v_mov_b32 v117, 0
    v_mov_b32 v118, 0
    v_mov_b32 v119, 0
    v_mov_b32 v120, 0
    v_mov_b32 v121, 0
    v_mov_b32 v122, 0
    v_mov_b32 v123, 0
    v_mov_b32 v124, 0
    v_mov_b32 v125, 0
    v_mov_b32 v126, 0
    v_mov_b32 v127, 0
    v_mov_b32 v128, 0
    v_mov_b32 v129, 0
    v_mov_b32 v130, 0
    v_mov_b32 v131, 0
    v_mov_b32 v132, 0
    v_mov_b32 v133, 0
    v_mov_b32 v134, 0
    v_mov_b32 v135, 0
    v_mov_b32 v136, 0
    v_mov_b32 v137, 0
    v_mov_b32 v138, 0
    v_mov_b32 v139, 0
    v_mov_b32 v140, 0
    v_mov_b32 v141, 0
    v_mov_b32 v142, 0
    v_mov_b32 v143, 0
    s_lshr_b32 s20, s2, 4
    s_lshl_b32 s20, s20, 7
    s_and_b32 s21, s2, 15
    s_lshl_b32 s21, s21, 2
    s_add_u32 s20, s20, s21
    s_add_u32 s20, s20, 4096
    v_lshl_add_u32 v2, v1, 11, s20
    s_mov_b32 s10, 106496
    s_mov_b32 s11, 4
    s_add_u32 s37, s37, 2097152
    s_lshl_b32 s20, s12, 10
    s_add_u32 s20, s20, 32768
    v_lshl_add_u32 v12, v8, 7, s20
a1_loop:
    v_add_u32 v188, s10, v180
    v_add_u32 v189, s10, v181
    v_add_u32 v190, s10, v182
    v_add_u32 v191, s10, v183
    v_add_u32 v192, s10, v184
    v_add_u32 v193, s10, v185
    v_add_u32 v194, s10, v186
    v_add_u32 v195, s10, v187
    s_add_u32 s10, s10, 24576
    s_cmp_ge_u32 s10, 155648
    s_cselect_b32 s10, 8192, s10
    s_cmp_lg_u32 s11, 3
    s_cbranch_scc1 a1_nb
    s_waitcnt vmcnt(0)
    s_barrier
    s_cmp_lg_u32 s3, 0
    s_cbranch_scc1 ow_1
    s_mov_b64 exec, 0xff
    buffer_store_dword v244, v2, s[32:35], 0 offen sc1
    s_mov_b64 exec, -1
ow_1:
    buffer_store_dwordx4 v[144:147], v13, s[24:27], s37 offen offset:0 sc1
    buffer_store_dwordx4 v[148:151], v13, s[24:27], s37 offen offset:1024 sc1
    s_branch a1_go
a1_nb:
    s_barrier
a1_go:
    s_cmp_lg_u32 s11, 1
    s_cbranch_scc1 a1_ns
a1_ns:
    ds_read_b128 v[48:51], v188
    ds_read_b128 v[52:55], v192
    ds_read_b128 v[56:59], v192 offset:4096
    v_mfma_f32_32x32x16_bf16 v[16:31], v[96:99], v[100:103], v[16:31]
    v_mfma_f32_32x32x16_bf16 v[32:47], v[96:99], v[104:107], v[32:47]
    v_dot2c_f32_bf16 v196, v100, v198
    v_dot2c_f32_bf16 v197, v104, v198
    v_dot2c_f32_bf16 v196, v101, v198
    v_dot2c_f32_bf16 v197, v105, v198
    v_dot2c_f32_bf16 v196, v102, v198
    v_dot2c_f32_bf16 v197, v106, v198
    v_dot2c_f32_bf16 v196, v103, v198
    v_dot2c_f32_bf16 v197, v107, v198
    ds_read_b128 v[60:63], v189
    ds_read_b128 v[64:67], v193
    ds_read_b128 v[68:71], v193 offset:4096
    v_mfma_f32_32x32x16_bf16 v[16:31], v[108:111], v[112:115], v[16:31]
    v_mfma_f32_32x32x16_bf16 v[32:47], v[108:111], v[116:119], v[32:47]
    ds_read_b128 v[72:75], v190
    ds_read_b128 v[76:79], v194
    ds_read_b128 v[80:83], v194 offset:4096
    v_mfma_f32_32x32x16_bf16 v[16:31], v[120:123], v[124:127], v[16:31]
    v_mfma_f32_32x32x16_bf16 v[32:47], v[120:123], v[128:131], v[32:47]
    ds_read_b128 v[84:87], v191
    ds_read_b128 v[88:91], v195
    ds_read_b128 v[92:95], v195 offset:4096
    v_mfma_f32_32x32x16_bf16 v[16:31], v[132:135], v[136:139], v[16:31]
    v_mfma_f32_32x32x16_bf16 v[32:47], v[132:135], v[140:143], v[32:47]
    v_add_u32 v188, s10, v180
    v_add_u32 v189, s10, v181
    v_add_u32 v190, s10, v182
    v_add_u32 v191, s10, v183
    v_add_u32 v192, s10, v184
    v_add_u32 v193, s10, v185
    v_add_u32 v194, s10, v186
    v_add_u32 v195, s10, v187
    s_add_u32 s10, s10, 24576
    s_cmp_ge_u32 s10, 155648
    s_cselect_b32 s10, 8192, s10
    ds_read_b128 v[96:99], v188
    ds_read_b128 v[100:103], v192
    ds_read_b128 v[104:107], v192 offset:4096
    s_waitcnt lgkmcnt(12)
    v_mfma_f32_32x32x16_bf16 v[16:31], v[48:51], v[52:55], v[16:31]
    v_mfma_f32_32x32x16_bf16 v[32:47], v[48:51], v[56:59], v[32:47]
    v_dot2c_f32_bf16 v196, v52, v198
    v_dot2c_f32_bf16 v197, v56, v198
    v_dot2c_f32_bf16 v196, v53, v198
    v_dot2c_f32_bf16 v197, v57, v198
    v_dot2c_f32_bf16 v196, v54, v198
    v_dot2c_f32_bf16 v197, v58, v198
    v_dot2c_f32_bf16 v196, v55, v198
    v_dot2c_f32_bf16 v197, v59, v198
    ds_read_b128 v[108:111], v189
    ds_read_b128 v[112:115], v193
    ds_read_b128 v[116:119], v193 offset:4096
    s_waitcnt lgkmcnt(12)
    v_mfma_f32_32x32x16_bf16 v[16:31], v[60:63], v[64:67], v[16:31]
    v_mfma_f32_32x32x16_bf16 v[32:47], v[60:63], v[68:71], v[32:47]
    ds_read_b128 v[120:123], v190
    ds_read_b128 v[124:127], v194
    ds_read_b128 v[128:131], v194 offset:4096
    s_waitcnt lgkmcnt(12)
    v_mfma_f32_32x32x16_bf16 v[16:31], v[72:75], v[76:79], v[16:31]
    v_mfma_f32_32x32x16_bf16 v[32:47], v[72:75], v[80:83], v[32:47]
    ds_read_b128 v[132:135], v191
    ds_read_b128 v[136:139], v195
    ds_read_b128 v[140:143], v195 offset:4096
    s_waitcnt lgkmcnt(12)
    v_mfma_f32_32x32x16_bf16 v[16:31], v[84:87], v[88:91], v[16:31]
    v_mfma_f32_32x32x16_bf16 v[32:47], v[84:87], v[92:95], v[32:47]
    s_waitcnt lgkmcnt(0)
    s_sub_u32 s11, s11, 1
    s_cmp_lg_u32 s11, 0
    s_cbranch_scc1 a1_loop
    v_mfma_f32_32x32x16_bf16 v[16:31], v[96:99], v[100:103], v[16:31]
    v_mfma_f32_32x32x16_bf16 v[32:47], v[96:99], v[104:107], v[32:47]
    v_dot2c_f32_bf16 v196, v100, v198
    v_dot2c_f32_bf16 v197, v104, v198
    v_dot2c_f32_bf16 v196, v101, v198
    v_dot2c_f32_bf16 v197, v105, v198
    v_dot2c_f32_bf16 v196, v102, v198
    v_dot2c_f32_bf16 v197, v106, v198
    v_dot2c_f32_bf16 v196, v103, v198
    v_dot2c_f32_bf16 v197, v107, v198
    v_lshlrev_b32 v13, 3, v0
    s_nop 2
    ds_write_b64 v13, v[196:197] offset:4864
    v_mfma_f32_32x32x16_bf16 v[16:31], v[108:111], v[112:115], v[16:31]
    v_mfma_f32_32x32x16_bf16 v[32:47], v[108:111], v[116:119], v[32:47]
    v_mfma_f32_32x32x16_bf16 v[16:31], v[120:123], v[124:127], v[16:31]
    v_mfma_f32_32x32x16_bf16 v[32:47], v[120:123], v[128:131], v[32:47]
    v_mfma_f32_32x32x16_bf16 v[16:31], v[132:135], v[136:139], v[16:31]
    v_mfma_f32_32x32x16_bf16 v[32:47], v[132:135], v[140:143], v[32:47]
    v_lshlrev_b32 v2, 3, v3
    s_waitcnt lgkmcnt(0)
    s_barrier
    s_waitcnt vmcnt(0)
    v_lshlrev_b32 v6, 7, v8
    ds_read_b128 v[144:147], v6 offset:0
    ds_read_b128 v[148:151], v6 offset:16
    ds_read_b128 v[152:155], v6 offset:32
    ds_read_b128 v[156:159], v6 offset:48
    ds_read_b128 v[160:163], v6 offset:64
    ds_read_b128 v[164:167], v6 offset:80
    ds_read_b128 v[168:171], v6 offset:96
    ds_read_b128 v[172:175], v6 offset:112
    ds_read_b64 v[112:113], v2 offset:4864
    ds_read_b64 v[114:115], v2 offset:5120
    ds_read_b64 v[116:117], v2 offset:5376
    ds_read_b64 v[118:119], v2 offset:5632
    ds_read_b64 v[120:121], v2 offset:5888
    ds_read_b64 v[122:123], v2 offset:6144
    ds_read_b64 v[124:125], v2 offset:6400
    ds_read_b64 v[126:127], v2 offset:6656
    s_waitcnt lgkmcnt(0)
    s_mov_b32 s36, 100000
pt_3:
    s_waitcnt vmcnt(0)
    v_cmp_ne_u32 s[20:21], v147, v244
    v_cmp_ne_u32 vcc, v151, v244
    s_or_b64 s[20:21], s[20:21], vcc
    v_cmp_ne_u32 vcc, v155, v244
    s_or_b64 s[20:21], s[20:21], vcc
    v_cmp_ne_u32 vcc, v159, v244
    s_or_b64 s[20:21], s[20:21], vcc
    v_cmp_ne_u32 vcc, v163, v244
    s_or_b64 s[20:21], s[20:21], vcc
    v_cmp_ne_u32 vcc, v167, v244
    s_or_b64 s[20:21], s[20:21], vcc
    v_cmp_ne_u32 vcc, v171, v244
    s_or_b64 s[20:21], s[20:21], vcc
    v_cmp_ne_u32 vcc, v175, v244
    s_or_b64 s[20:21], s[20:21], vcc
    s_cmp_eq_u64 s[20:21], 0
    s_cbranch_scc1 pd_2
    s_sub_u32 s36, s36, 1
    s_cbranch_scc1 pd_2
    s_mov_b32 s20, 40
dl_4:
    s_sub_u32 s20, s20, 1
    s_cbranch_scc0 dl_4
    buffer_load_dwordx4 v[144:147], v12, s[32:35], 0 offen offset:0 sc1
    buffer_load_dwordx4 v[148:151], v12, s[32:35], 0 offen offset:16 sc1
    buffer_load_dwordx4 v[152:155], v12, s[32:35], 0 offen offset:32 sc1
    buffer_load_dwordx4 v[156:159], v12, s[32:35], 0 offen offset:48 sc1
    buffer_load_dwordx4 v[160:163], v12, s[32:35], 0 offen offset:64 sc1
    buffer_load_dwordx4 v[164:167], v12, s[32:35], 0 offen offset:80 sc1
    buffer_load_dwordx4 v[168:171], v12, s[32:35], 0 offen offset:96 sc1
    buffer_load_dwordx4 v[172:175], v12, s[32:35], 0 offen offset:112 sc1
    s_branch pt_3
pd_2:
    v_pk_add_f32 v[218:219], v[112:113], v[114:115]
    v_pk_add_f32 v[218:219], v[218:219], v[116:117]
    v_pk_add_f32 v[218:219], v[218:219], v[118:119]
    v_pk_add_f32 v[218:219], v[218:219], v[120:121]
    v_pk_add_f32 v[218:219], v[218:219], v[122:123]
    v_pk_add_f32 v[218:219], v[218:219], v[124:125]
    v_pk_add_f32 v[218:219], v[218:219], v[126:127]
    v_mov_b32 v192, 0
    v_mov_b32 v193, 0
    v_lshlrev_b32 v2, 16, v144
    v_fma_f32 v16, -v2, v218, v16
    v_fma_f32 v32, -v2, v219, v32
    v_mul_f32 v16, v16, v145
    v_mul_f32 v32, v32, v145
    v_fma_f32 v194, v204, v192, v16
    v_fma_f32 v195, v204, v193, v32
    v_fma_f32 v194, -v205, v193, v194
    v_fma_f32 v195, v205, v192, v195
    v_and_b32 v2, 0xffff0000, v144
    v_fma_f32 v17, -v2, v218, v17
    v_fma_f32 v33, -v2, v219, v33
    v_mul_f32 v17, v17, v146
    v_mul_f32 v33, v33, v146
    v_fma_f32 v192, v204, v194, v17
    v_fma_f32 v193, v204, v195, v33
    v_fma_f32 v192, -v205, v195, v192
    v_fma_f32 v193, v205, v194, v193
    v_lshlrev_b32 v2, 16, v148
    v_fma_f32 v18, -v2, v218, v18
    v_fma_f32 v34, -v2, v219, v34
    v_mul_f32 v18, v18, v149
    v_mul_f32 v34, v34, v149
    v_fma_f32 v194, v204, v192, v18
    v_fma_f32 v195, v204, v193, v34
    v_fma_f32 v194, -v205, v193, v194
    v_fma_f32 v195, v205, v192, v195
    v_and_b32 v2, 0xffff0000, v148
    v_fma_f32 v19, -v2, v218, v19
    v_fma_f32 v35, -v2, v219, v35
    v_mul_f32 v19, v19, v150
    v_mul_f32 v35, v35, v150
    v_fma_f32 v192, v204, v194, v19
    v_fma_f32 v193, v204, v195, v35
    v_fma_f32 v192, -v205, v195, v192
    v_fma_f32 v193, v205, v194, v193
    v_lshlrev_b32 v2, 16, v152
    v_fma_f32 v20, -v2, v218, v20
    v_fma_f32 v36, -v2, v219, v36
    v_mul_f32 v20, v20, v153
    v_mul_f32 v36, v36, v153
    v_fma_f32 v194, v204, v192, v20
    v_fma_f32 v195, v204, v193, v36
    v_fma_f32 v194, -v205, v193, v194
    v_fma_f32 v195, v205, v192, v195
    v_and_b32 v2, 0xffff0000, v152
    v_fma_f32 v21, -v2, v218, v21
    v_fma_f32 v37, -v2, v219, v37
    v_mul_f32 v21, v21, v154
    v_mul_f32 v37, v37, v154
    v_fma_f32 v192, v204, v194, v21
    v_fma_f32 v193, v204, v195, v37
    v_fma_f32 v192, -v205, v195, v192
    v_fma_f32 v193, v205, v194, v193
    v_lshlrev_b32 v2, 16, v156
    v_fma_f32 v22, -v2, v218, v22
    v_fma_f32 v38, -v2, v219, v38
    v_mul_f32 v22, v22, v157
    v_mul_f32 v38, v38, v157
    v_fma_f32 v194, v204, v192, v22
    v_fma_f32 v195, v204, v193, v38
    v_fma_f32 v194, -v205, v193, v194
    v_fma_f32 v195, v205, v192, v195
    v_and_b32 v2, 0xffff0000, v156
    v_fma_f32 v23, -v2, v218, v23
    v_fma_f32 v39, -v2, v219, v39
    v_mul_f32 v23, v23, v158
    v_mul_f32 v39, v39, v158
    v_fma_f32 v192, v204, v194, v23
    v_fma_f32 v193, v204, v195, v39
    v_fma_f32 v192, -v205, v195, v192
    v_fma_f32 v193, v205, v194, v193
    v_lshlrev_b32 v2, 16, v160
    v_fma_f32 v24, -v2, v218, v24
    v_fma_f32 v40, -v2, v219, v40
    v_mul_f32 v24, v24, v161
    v_mul_f32 v40, v40, v161
    v_fma_f32 v194, v204, v192, v24
    v_fma_f32 v195, v204, v193, v40
    v_fma_f32 v194, -v205, v193, v194
    v_fma_f32 v195, v205, v192, v195
    v_and_b32 v2, 0xffff0000, v160
    v_fma_f32 v25, -v2, v218, v25
    v_fma_f32 v41, -v2, v219, v41
    v_mul_f32 v25, v25, v162
    v_mul_f32 v41, v41, v162
    v_fma_f32 v192, v204, v194, v25
    v_fma_f32 v193, v204, v195, v41
    v_fma_f32 v192, -v205, v195, v192
    v_fma_f32 v193, v205, v194, v193
    v_lshlrev_b32 v2, 16, v164
    v_fma_f32 v26, -v2, v218, v26
    v_fma_f32 v42, -v2, v219, v42
    v_mul_f32 v26, v26, v165
    v_mul_f32 v42, v42, v165
    v_fma_f32 v194, v204, v192, v26
    v_fma_f32 v195, v204, v193, v42
    v_fma_f32 v194, -v205, v193, v194
    v_fma_f32 v195, v205, v192, v195
    v_and_b32 v2, 0xffff0000, v164
    v_fma_f32 v27, -v2, v218, v27
    v_fma_f32 v43, -v2, v219, v43
    v_mul_f32 v27, v27, v166
    v_mul_f32 v43, v43, v166
    v_fma_f32 v192, v204, v194, v27
    v_fma_f32 v193, v204, v195, v43
    v_fma_f32 v192, -v205, v195, v192
    v_fma_f32 v193, v205, v194, v193
    v_lshlrev_b32 v2, 16, v168
    v_fma_f32 v28, -v2, v218, v28
    v_fma_f32 v44, -v2, v219, v44
    v_mul_f32 v28, v28, v169
    v_mul_f32 v44, v44, v169
    v_fma_f32 v194, v204, v192, v28
    v_fma_f32 v195, v204, v193, v44
    v_fma_f32 v194, -v205, v193, v194
    v_fma_f32 v195, v205, v192, v195
    v_and_b32 v2, 0xffff0000, v168
    v_fma_f32 v29, -v2, v218, v29
    v_fma_f32 v45, -v2, v219, v45
    v_mul_f32 v29, v29, v170
    v_mul_f32 v45, v45, v170
    v_fma_f32 v192, v204, v194, v29
    v_fma_f32 v193, v204, v195, v45
    v_fma_f32 v192, -v205, v195, v192
    v_fma_f32 v193, v205, v194, v193
    v_lshlrev_b32 v2, 16, v172
    v_fma_f32 v30, -v2, v218, v30
    v_fma_f32 v46, -v2, v219, v46
    v_mul_f32 v30, v30, v173
    v_mul_f32 v46, v46, v173
    v_fma_f32 v194, v204, v192, v30
    v_fma_f32 v195, v204, v193, v46
    v_fma_f32 v194, -v205, v193, v194
    v_fma_f32 v195, v205, v192, v195
    v_and_b32 v2, 0xffff0000, v172
    v_fma_f32 v31, -v2, v218, v31
    v_fma_f32 v47, -v2, v219, v47
    v_mul_f32 v31, v31, v174
    v_mul_f32 v47, v47, v174
    v_fma_f32 v192, v204, v194, v31
    v_fma_f32 v193, v204, v195, v47
    v_fma_f32 v192, -v205, v195, v192
    v_fma_f32 v193, v205, v194, v193
    ds_write_b64 v13, v[192:193] offset:2816
    s_lshl_b32 s20, s12, 13
    s_lshl_b32 s21, s13, 9
    s_add_u32 s20, s20, s21
    v_lshl_add_u32 v12, v3, 4, s20
    v_mov_b32 v190, v244
    v_mov_b32 v191, v244
    s_add_u32 s56, s16, 14745600
    s_addc_u32 s57, s17, 0
    s_mov_b32 s58, 131072
    s_mov_b32 s59, 0x00020000
    s_waitcnt lgkmcnt(0)
    s_barrier
    ds_read_b64_tr_b16 v[48:49], v176 offset:0
    ds_read_b64_tr_b16 v[50:51], v176 offset:512
    ds_read_b64_tr_b16 v[52:53], v178 offset:0
    ds_read_b64_tr_b16 v[54:55], v178 offset:512
    ds_read_b64_tr_b16 v[56:57], v176 offset:2048
    ds_read_b64_tr_b16 v[58:59], v176 offset:2560
    ds_read_b64_tr_b16 v[60:61], v178 offset:2048
    ds_read_b64_tr_b16 v[62:63], v178 offset:2560
    ds_read_b64_tr_b16 v[64:65], v176 offset:4096
    ds_read_b64_tr_b16 v[66:67], v176 offset:4608
    ds_read_b64_tr_b16 v[68:69], v178 offset:4096
    ds_read_b64_tr_b16 v[70:71], v178 offset:4608
    ds_read_b64_tr_b16 v[72:73], v176 offset:6144
    ds_read_b64_tr_b16 v[74:75], v176 offset:6656
    ds_read_b64_tr_b16 v[76:77], v178 offset:6144
    ds_read_b64_tr_b16 v[78:79], v178 offset:6656
    ds_read_b64_tr_b16 v[80:81], v176 offset:16384
    ds_read_b64_tr_b16 v[82:83], v176 offset:16896
    ds_read_b64_tr_b16 v[84:85], v178 offset:16384
    ds_read_b64_tr_b16 v[86:87], v178 offset:16896
    s_waitcnt lgkmcnt(12)
    v_mfma_f32_32x32x16_bf16 v[144:159], v[52:55], v[48:51], 0
    ds_read_b64_tr_b16 v[88:89], v176 offset:18432
    ds_read_b64_tr_b16 v[90:91], v176 offset:18944
    ds_read_b64_tr_b16 v[92:93], v178 offset:18432
    ds_read_b64_tr_b16 v[94:95], v178 offset:18944
    v_mfma_f32_32x32x16_bf16 v[144:159], v[60:63], v[56:59], v[144:159]
    ds_read_b64_tr_b16 v[96:97], v176 offset:20480
    ds_read_b64_tr_b16 v[98:99], v176 offset:20992
    ds_read_b64_tr_b16 v[100:101], v178 offset:20480
    ds_read_b64_tr_b16 v[102:103], v178 offset:20992
    s_waitcnt lgkmcnt(12)
    v_mfma_f32_32x32x16_bf16 v[144:159], v[68:71], v[64:67], v[144:159]
    ds_read_b64_tr_b16 v[104:105], v176 offset:22528
    ds_read_b64_tr_b16 v[106:107], v176 offset:23040
    ds_read_b64_tr_b16 v[108:109], v178 offset:22528
    ds_read_b64_tr_b16 v[110:111], v178 offset:23040
    v_mfma_f32_32x32x16_bf16 v[144:159], v[76:79], v[72:75], v[144:159]
    ds_read_b64 v[112:113], v13 offset:1024
    ds_read_b64 v[114:115], v13 offset:1280
    ds_read_b64 v[116:117], v13 offset:1536
    ds_read_b64 v[118:119], v13 offset:1792
    ds_read_b64 v[120:121], v13 offset:2048
    ds_read_b64 v[122:123], v13 offset:2304
    ds_read_b64 v[124:125], v13 offset:2560
    s_or_b32 s20, s2, s3
    s_cmp_lg_u32 s20, 0
    s_cbranch_scc1 ep_5
    s_mov_b64 exec, 1
    buffer_store_dword v244, v14, s[32:35], 0 offen sc1
    s_mov_b64 exec, -1
ep_5:
    s_waitcnt lgkmcnt(0)
    v_fma_f32 v194, v206, v112, v114
    v_fma_f32 v195, v206, v113, v115
    v_fma_f32 v194, -v207, v113, v194
    v_fma_f32 v195, v207, v112, v195
    v_fma_f32 v216, v206, v194, v116
    v_fma_f32 v217, v206, v195, v117
    v_fma_f32 v216, -v207, v195, v216
    v_fma_f32 v217, v207, v194, v217
    v_fma_f32 v194, v206, v216, v118
    v_fma_f32 v195, v206, v217, v119
    v_fma_f32 v194, -v207, v217, v194
    v_fma_f32 v195, v207, v216, v195
    v_fma_f32 v216, v206, v194, v120
    v_fma_f32 v217, v206, v195, v121
    v_fma_f32 v216, -v207, v195, v216
    v_fma_f32 v217, v207, v194, v217
    v_fma_f32 v194, v206, v216, v122
    v_fma_f32 v195, v206, v217, v123
    v_fma_f32 v194, -v207, v217, v194
    v_fma_f32 v195, v207, v216, v195
    v_fma_f32 v216, v206, v194, v124
    v_fma_f32 v217, v206, v195, v125
    v_fma_f32 v216, -v207, v195, v216
    v_fma_f32 v217, v207, v194, v217
    s_cmp_lg_u32 s3, 3
    s_cbranch_scc1 ow_6
    v_fma_f32 v188, v206, v216, v192
    v_fma_f32 v189, v206, v217, v193
    v_fma_f32 v188, -v207, v217, v188
    v_fma_f32 v189, v207, v216, v189
    s_mov_b32 exec_lo, 0
    buffer_store_dwordx4 v[188:191], v12, s[56:59], 0 offen sc1
    s_mov_b32 exec_lo, -1
ow_6:
    s_mov_b32 s11, 0
    s_call_b64 s[38:39], kk_sub1
    v_cvt_f32_u32 v199, v8
    v_mul_f32 v199, 0x41800000, v199
    v_mul_f32 v208, v199, v202
    v_mul_f32 v2, v199, v203
    v_exp_f32 v208, v208
    v_fract_f32 v2, v2
    v_sin_f32 v209, v2
    v_cos_f32 v2, v2
    s_nop 0
    v_mul_f32 v209, v209, v208
    v_mul_f32 v208, v2, v208
    v_mul_f32 v212, 0x43000000, v202
    v_mul_f32 v2, 0x43000000, v203
    v_exp_f32 v212, v212
    v_fract_f32 v2, v2
    v_sin_f32 v213, v2
    v_cos_f32 v2, v2
    s_nop 0
    v_mul_f32 v213, v213, v212
    v_mul_f32 v212, v2, v212
    v_mul_f32 v214, 0x43800000, v202
    v_mul_f32 v2, 0x43800000, v203
    v_exp_f32 v214, v214
    v_fract_f32 v2, v2
    v_sin_f32 v215, v2
    v_cos_f32 v2, v2
    s_nop 0
    v_mul_f32 v215, v215, v214
    v_mul_f32 v214, v2, v214
    v_add_f32 v2, -1.0, v204
    v_mul_f32 v199, v200, v200
    v_fma_f32 v199, v201, v201, v199
    v_rcp_f32 v199, v199
    v_mul_f32 v210, v2, v200
    v_fma_f32 v210, v205, v201, v210
    v_mul_f32 v211, v205, v200
    v_fma_f32 v211, -v2, v201, v211
    v_add_f32 v199, v199, v199
    v_mul_f32 v210, v210, v199
    v_mul_f32 v211, v211, v199
    s_mov_b32 s11, 0
    s_call_b64 s[38:39], kk_sub2
    v_lshlrev_b32 v6, 13, v7
    v_sub_u32 v220, v12, v6
    v_subrev_u32 v220, 8192, v220
    v_subrev_u32 v221, 16384, v220
    v_subrev_u32 v222, 32768, v220
    v_subrev_u32 v223, 49152, v220
    v_subrev_u32 v224, 65536, v220
    v_subrev_u32 v225, 81920, v220
    v_subrev_u32 v226, 98304, v220
    v_subrev_u32 v227, 114688, v220
    v_ashrrev_i32 v2, 31, v220
    v_bfi_b32 v228, v2, 0, v244
    v_ashrrev_i32 v2, 31, v221
    v_bfi_b32 v229, v2, 0, v244
    v_ashrrev_i32 v2, 31, v222
    v_bfi_b32 v230, v2, 0, v244
    v_ashrrev_i32 v2, 31, v223
    v_bfi_b32 v231, v2, 0, v244
    v_ashrrev_i32 v2, 31, v224
    v_bfi_b32 v232, v2, 0, v244
    v_ashrrev_i32 v2, 31, v225
    v_bfi_b32 v233, v2, 0, v244
    v_ashrrev_i32 v2, 31, v226
    v_bfi_b32 v234, v2, 0, v244
    v_ashrrev_i32 v2, 31, v227
    v_bfi_b32 v235, v2, 0, v244
    s_lshl_b32 s20, s12, 8
    s_lshl_b32 s21, s13, 4
    s_add_u32 s20, s20, s21
    s_lshl2_add_u32 s20, s3, s20
    s_add_u32 s20, s20, 24576
    v_mov_b32 v246, s20
    s_lshl_b32 s20, s48, 9
    s_lshl_b32 s21, s49, 4
    s_add_u32 s20, s20, s21
    s_lshl2_add_u32 s20, s3, s20
    s_add_u32 s20, s20, 28672
    s_orn2_b32 s20, s20, s50
    v_mov_b32 v248, s20
    s_mov_b32 s9, 0
    s_mov_b32 s28, s90
    s_mov_b32 s29, s91
    s_mov_b32 s30, 2752
    s_mov_b32 s31, 0x00020000
    s_lshl_b32 s21, s55, 6
    s_lshl_b32 s20, s49, 7
    s_add_u32 s21, s21, s20
    v_lshl_add_u32 v6, v7, 3, s21
    buffer_load_dwordx2 v[240:241], v6, s[28:31], 0 offen offset:0
    buffer_load_dwordx2 v[242:243], v6, s[28:31], 0 offen offset:16
    buffer_load_dwordx2 v[196:197], v6, s[28:31], 0 offen offset:32
    buffer_load_dwordx2 v[192:193], v6, s[28:31], 0 offen offset:48
    s_lshl_b32 s21, s21, 9
    s_lshl_b32 s20, s54, 9
    v_lshlrev_b32 v237, 4, v3
    v_add_u32 v236, s20, v237
    s_add_u32 s21, s21, s20
    s_lshl_b32 s20, s48, 10
    s_add_u32 s21, s21, s20
    v_lshl_add_u32 v237, v7, 3, v237
    v_add_u32 v237, s21, v237
    v_lshl_add_u32 v236, v7, 10, v236
    v_add_u32 v236, 8192, v236
    v_and_b32 v194, 1, v1
    v_lshlrev_b32 v194, 3, v194
    v_bfe_u32 v195, v1, 1, 1
    v_lshl_add_u32 v194, v195, 6, v194
    v_bfe_u32 v195, v1, 4, 1
    v_lshl_add_u32 v194, v195, 7, v194
    v_bfe_u32 v195, v1, 2, 2
    v_lshl_add_u32 v194, v195, 4, v194
    v_lshl_add_u32 v194, v7, 9, v194
    s_lshl_b32 s20, s55, 12
    s_add_u32 s20, s20, 16384
    v_add_u32 v194, s20, v194
    v_add_u32 v195, 0x10000, v194
    s_mov_b32 s11, 0
    s_call_b64 s[38:39], kk_sub3
    buffer_load_dwordx4 v[112:115], v220, s[56:59], 0 offen sc1
    buffer_load_dwordx4 v[116:119], v221, s[56:59], 0 offen sc1
    buffer_load_dwordx4 v[120:123], v222, s[56:59], 0 offen sc1
    buffer_load_dwordx4 v[124:127], v223, s[56:59], 0 offen sc1
    buffer_load_dwordx4 v[128:131], v224, s[56:59], 0 offen sc1
    buffer_load_dwordx4 v[132:135], v225, s[56:59], 0 offen sc1
    buffer_load_dwordx4 v[136:139], v226, s[56:59], 0 offen sc1
    buffer_load_dwordx4 v[140:143], v227, s[56:59], 0 offen sc1
    v_mul_f32 v2, v211, v16
    v_mul_f32 v16, v210, v16
    v_fma_f32 v16, -v211, v32, v16
    v_fma_f32 v32, v210, v32, v2
    v_mul_f32 v2, v211, v17
    v_mul_f32 v17, v210, v17
    v_fma_f32 v17, -v211, v33, v17
    v_fma_f32 v33, v210, v33, v2
    v_mul_f32 v2, v211, v18
    v_mul_f32 v18, v210, v18
    v_fma_f32 v18, -v211, v34, v18
    v_fma_f32 v34, v210, v34, v2
    v_mul_f32 v2, v211, v19
    v_mul_f32 v19, v210, v19
    v_fma_f32 v19, -v211, v35, v19
    v_fma_f32 v35, v210, v35, v2
    v_mul_f32 v2, v211, v20
    v_mul_f32 v20, v210, v20
    v_fma_f32 v20, -v211, v36, v20
    v_fma_f32 v36, v210, v36, v2
    v_mul_f32 v2, v211, v21
    v_mul_f32 v21, v210, v21
    v_fma_f32 v21, -v211, v37, v21
    v_fma_f32 v37, v210, v37, v2
    v_mul_f32 v2, v211, v22
    v_mul_f32 v22, v210, v22
    v_fma_f32 v22, -v211, v38, v22
    v_fma_f32 v38, v210, v38, v2
    s_mov_b32 s11, 0
    s_call_b64 s[38:39], kk_sub0
    v_mul_f32 v2, v211, v23
    v_mul_f32 v23, v210, v23
    v_fma_f32 v23, -v211, v39, v23
    v_fma_f32 v39, v210, v39, v2
    v_mul_f32 v2, v211, v24
    v_mul_f32 v24, v210, v24
    v_fma_f32 v24, -v211, v40, v24
    v_fma_f32 v40, v210, v40, v2
    v_mul_f32 v2, v211, v25
    v_mul_f32 v25, v210, v25
    v_fma_f32 v25, -v211, v41, v25
    v_fma_f32 v41, v210, v41, v2
    v_mul_f32 v2, v211, v26
    v_mul_f32 v26, v210, v26
    v_fma_f32 v26, -v211, v42, v26
    v_fma_f32 v42, v210, v42, v2
    v_mul_f32 v2, v211, v27
    v_mul_f32 v27, v210, v27
    v_fma_f32 v27, -v211, v43, v27
    v_fma_f32 v43, v210, v43, v2
    v_mul_f32 v2, v211, v28
    v_mul_f32 v28, v210, v28
    v_fma_f32 v28, -v211, v44, v28
    v_fma_f32 v44, v210, v44, v2
    v_mul_f32 v2, v211, v29
    v_mul_f32 v29, v210, v29
    v_fma_f32 v29, -v211, v45, v29
    v_fma_f32 v45, v210, v45, v2
    v_mul_f32 v2, v211, v30
    v_mul_f32 v30, v210, v30
    v_fma_f32 v30, -v211, v46, v30
    v_fma_f32 v46, v210, v46, v2
    v_mul_f32 v2, v211, v31
    v_mul_f32 v31, v210, v31
    v_fma_f32 v31, -v211, v47, v31
    v_fma_f32 v47, v210, v47, v2
    s_mov_b32 s11, 0
    s_call_b64 s[38:39], kk_sub1
    s_cmp_ge_u32 s9, 3
    s_cbranch_scc1 ev_7
    s_call_b64 s[100:101], ev_sub
ev_7:
    s_mov_b32 s11, 0
    s_call_b64 s[38:39], kk_sub2
    s_cmp_ge_u32 s9, 3
    s_cbranch_scc1 ev_8
    s_call_b64 s[100:101], ev_sub
ev_8:
    v_xor_b32 v180, 0, v245
    v_add_u32 v184, 0x10000, v180
    v_xor_b32 v181, 32, v245
    v_add_u32 v185, 0x10000, v181
    v_xor_b32 v182, 64, v245
    v_add_u32 v186, 0x10000, v182
    v_xor_b32 v183, 96, v245
    v_add_u32 v187, 0x10000, v183
    s_mov_b32 s11, 0
    s_call_b64 s[38:39], kk_sub3
    s_cmp_ge_u32 s9, 3
    s_cbranch_scc1 ev_9
    s_call_b64 s[100:101], ev_sub
ev_9:
    s_mov_b32 s11, 0
    s_call_b64 s[38:39], kk_sub0
    s_cmp_ge_u32 s9, 3
    s_cbranch_scc1 ev_10
    s_call_b64 s[100:101], ev_sub
ev_10:
    s_mov_b32 s11, 0
    s_call_b64 s[38:39], kk_sub1
    s_cmp_ge_u32 s9, 3
    s_cbranch_scc1 ev_11
    s_call_b64 s[100:101], ev_sub
ev_11:
    s_mov_b32 s11, 0
    s_call_b64 s[38:39], kk_sub2
    s_cmp_ge_u32 s9, 3
    s_cbranch_scc1 ev_12
    s_call_b64 s[100:101], ev_sub
ev_12:
    s_mov_b32 s11, 0
    s_call_b64 s[38:39], kk_sub3
    s_cmp_ge_u32 s9, 3
    s_cbranch_scc1 ev_13
    s_call_b64 s[100:101], ev_sub
ev_13:
    s_mov_b32 s11, 0
    s_call_b64 s[38:39], kk_sub0
    s_cmp_ge_u32 s9, 3
    s_cbranch_scc1 ev_14
    s_call_b64 s[100:101], ev_sub
ev_14:
    s_mov_b32 s11, 0
    s_call_b64 s[38:39], kk_sub1
    s_cmp_ge_u32 s9, 3
    s_cbranch_scc1 ev_15
    s_call_b64 s[100:101], ev_sub
ev_15:
    s_mov_b32 s11, 0
    s_call_b64 s[38:39], kk_sub2
    s_cmp_ge_u32 s9, 3
    s_cbranch_scc1 ev_16
    s_call_b64 s[100:101], ev_sub
ev_16:
    s_mov_b32 s11, 0
    s_call_b64 s[38:39], kk_sub3
    s_waitcnt lgkmcnt(8)
    v_mfma_f32_32x32x16_bf16 v[144:159], v[84:87], v[80:83], v[144:159]
    v_mfma_f32_32x32x16_bf16 v[144:159], v[92:95], v[88:91], v[144:159]
    s_waitcnt lgkmcnt(0)
    v_mfma_f32_32x32x16_bf16 v[144:159], v[100:103], v[96:99], v[144:159]
    v_mfma_f32_32x32x16_bf16 v[144:159], v[108:111], v[104:107], v[144:159]
    s_add_u32 s24, s16, 8388608
    s_addc_u32 s25, s17, 0
    s_mov_b32 s26, 1409024
    s_mov_b32 s27, 0x00020000
    s_and_b32 s26, s26, s50
    s_mov_b32 s22, 0xc0135761
    s_mov_b32 s23, 0xbdd2d3e8
    v_mov_b32 v11, s22
    v_mov_b32 v176, v236
    v_add_u32 v177, 0x10000, v236
    s_waitcnt vmcnt(0)
    v_lshlrev_b32 v48, 16, v240
    v_and_b32 v49, 0xffff0000, v240
    v_lshlrev_b32 v50, 16, v241
    v_and_b32 v51, 0xffff0000, v241
    v_lshlrev_b32 v52, 16, v242
    v_and_b32 v53, 0xffff0000, v242
    v_lshlrev_b32 v54, 16, v243
    v_and_b32 v55, 0xffff0000, v243
    v_lshlrev_b32 v56, 16, v196
    v_and_b32 v57, 0xffff0000, v196
    v_lshlrev_b32 v58, 16, v197
    v_and_b32 v59, 0xffff0000, v197
    v_lshlrev_b32 v60, 16, v192
    v_and_b32 v61, 0xffff0000, v192
    v_lshlrev_b32 v62, 16, v193
    v_and_b32 v63, 0xffff0000, v193
    v_mov_b32 v10, v11
    v_mov_b32 v128, s23
    v_mov_b32 v129, s23
    v_mov_b32 v130, 1.0
    v_mov_b32 v131, 1.0
    v_cvt_pk_bf16_f32 v12, v144, v145
    v_lshlrev_b32 v144, 16, v12
    v_and_b32 v145, 0xffff0000, v12
    v_cvt_pk_bf16_f32 v13, v146, v147
    v_lshlrev_b32 v146, 16, v13
    v_and_b32 v147, 0xffff0000, v13
    v_pk_add_f32 v[144:145], v[144:145], v[48:49]
    v_pk_add_f32 v[146:147], v[146:147], v[50:51]
    v_cvt_pk_bf16_f32 v12, v144, v145
    v_lshlrev_b32 v144, 16, v12
    v_and_b32 v145, 0xffff0000, v12
    v_cvt_pk_bf16_f32 v13, v146, v147
    v_lshlrev_b32 v146, 16, v13
    v_and_b32 v147, 0xffff0000, v13
    v_pk_mul_f32 v[112:113], v[144:145], v[144:145]
    v_pk_mul_f32 v[114:115], v[146:147], v[146:147]
    v_pk_fma_f32 v[112:113], v[112:113], v[128:129], v[10:11]
    v_pk_fma_f32 v[114:115], v[114:115], v[128:129], v[10:11]
    v_pk_mul_f32 v[112:113], v[112:113], v[144:145]
    v_pk_mul_f32 v[114:115], v[114:115], v[146:147]
    v_exp_f32 v112, v112
    v_exp_f32 v113, v113
    v_exp_f32 v114, v114
    v_exp_f32 v115, v115
    s_nop 0
    v_pk_add_f32 v[112:113], v[112:113], v[130:131]
    v_pk_add_f32 v[114:115], v[114:115], v[130:131]
    v_rcp_f32 v112, v112
    v_rcp_f32 v113, v113
    v_rcp_f32 v114, v114
    v_rcp_f32 v115, v115
    s_nop 0
    v_pk_mul_f32 v[112:113], v[112:113], v[144:145]
    v_pk_mul_f32 v[114:115], v[114:115], v[146:147]
    v_cvt_pk_bf16_f32 v120, v112, v113
    v_cvt_pk_bf16_f32 v121, v114, v115
    v_cvt_pk_bf16_f32 v12, v148, v149
    v_lshlrev_b32 v148, 16, v12
    v_and_b32 v149, 0xffff0000, v12
    v_cvt_pk_bf16_f32 v13, v150, v151
    v_lshlrev_b32 v150, 16, v13
    v_and_b32 v151, 0xffff0000, v13
    v_pk_add_f32 v[148:149], v[148:149], v[52:53]
    v_pk_add_f32 v[150:151], v[150:151], v[54:55]
    v_cvt_pk_bf16_f32 v12, v148, v149
    v_lshlrev_b32 v148, 16, v12
    v_and_b32 v149, 0xffff0000, v12
    v_cvt_pk_bf16_f32 v13, v150, v151
    v_lshlrev_b32 v150, 16, v13
    v_and_b32 v151, 0xffff0000, v13
    v_pk_mul_f32 v[116:117], v[148:149], v[148:149]
    v_pk_mul_f32 v[118:119], v[150:151], v[150:151]
    v_pk_fma_f32 v[116:117], v[116:117], v[128:129], v[10:11]
    v_pk_fma_f32 v[118:119], v[118:119], v[128:129], v[10:11]
    v_pk_mul_f32 v[116:117], v[116:117], v[148:149]
    v_pk_mul_f32 v[118:119], v[118:119], v[150:151]
    v_exp_f32 v116, v116
    v_exp_f32 v117, v117
    v_exp_f32 v118, v118
    v_exp_f32 v119, v119
    s_nop 0
    v_pk_add_f32 v[116:117], v[116:117], v[130:131]
    v_pk_add_f32 v[118:119], v[118:119], v[130:131]
    v_rcp_f32 v116, v116
    v_rcp_f32 v117, v117
    v_rcp_f32 v118, v118
    v_rcp_f32 v119, v119
    s_nop 0
    v_pk_mul_f32 v[116:117], v[116:117], v[148:149]
    v_pk_mul_f32 v[118:119], v[118:119], v[150:151]
    v_cvt_pk_bf16_f32 v122, v116, v117
    v_cvt_pk_bf16_f32 v123, v118, v119
    v_cvt_pk_bf16_f32 v12, v152, v153
    v_lshlrev_b32 v152, 16, v12
    v_and_b32 v153, 0xffff0000, v12
    v_cvt_pk_bf16_f32 v13, v154, v155
    v_lshlrev_b32 v154, 16, v13
    v_and_b32 v155, 0xffff0000, v13
    v_pk_add_f32 v[152:153], v[152:153], v[56:57]
    v_pk_add_f32 v[154:155], v[154:155], v[58:59]
    v_cvt_pk_bf16_f32 v12, v152, v153
    v_lshlrev_b32 v152, 16, v12
    v_and_b32 v153, 0xffff0000, v12
    v_cvt_pk_bf16_f32 v13, v154, v155
    v_lshlrev_b32 v154, 16, v13
    v_and_b32 v155, 0xffff0000, v13
    v_pk_mul_f32 v[112:113], v[152:153], v[152:153]
    v_pk_mul_f32 v[114:115], v[154:155], v[154:155]
    v_pk_fma_f32 v[112:113], v[112:113], v[128:129], v[10:11]
    v_pk_fma_f32 v[114:115], v[114:115], v[128:129], v[10:11]
    v_pk_mul_f32 v[112:113], v[112:113], v[152:153]
    v_pk_mul_f32 v[114:115], v[114:115], v[154:155]
    v_exp_f32 v112, v112
    v_exp_f32 v113, v113
    v_exp_f32 v114, v114
    v_exp_f32 v115, v115
    s_nop 0
    v_pk_add_f32 v[112:113], v[112:113], v[130:131]
    v_pk_add_f32 v[114:115], v[114:115], v[130:131]
    v_rcp_f32 v112, v112
    v_rcp_f32 v113, v113
    v_rcp_f32 v114, v114
    v_rcp_f32 v115, v115
    s_nop 0
    v_pk_mul_f32 v[112:113], v[112:113], v[152:153]
    v_pk_mul_f32 v[114:115], v[114:115], v[154:155]
    v_cvt_pk_bf16_f32 v124, v112, v113
    v_cvt_pk_bf16_f32 v125, v114, v115
    v_cvt_pk_bf16_f32 v12, v156, v157
    v_lshlrev_b32 v156, 16, v12
    v_and_b32 v157, 0xffff0000, v12
    v_cvt_pk_bf16_f32 v13, v158, v159
    v_lshlrev_b32 v158, 16, v13
    v_and_b32 v159, 0xffff0000, v13
    v_pk_add_f32 v[156:157], v[156:157], v[60:61]
    v_pk_add_f32 v[158:159], v[158:159], v[62:63]
    v_cvt_pk_bf16_f32 v12, v156, v157
    v_lshlrev_b32 v156, 16, v12
    v_and_b32 v157, 0xffff0000, v12
    v_cvt_pk_bf16_f32 v13, v158, v159
    v_lshlrev_b32 v158, 16, v13
    v_and_b32 v159, 0xffff0000, v13
    v_pk_mul_f32 v[116:117], v[156:157], v[156:157]
    v_pk_mul_f32 v[118:119], v[158:159], v[158:159]
    v_pk_fma_f32 v[116:117], v[116:117], v[128:129], v[10:11]
    v_pk_fma_f32 v[118:119], v[118:119], v[128:129], v[10:11]
    v_pk_mul_f32 v[116:117], v[116:117], v[156:157]
    v_pk_mul_f32 v[118:119], v[118:119], v[158:159]
    v_exp_f32 v116, v116
    v_exp_f32 v117, v117
    v_exp_f32 v118, v118
    v_exp_f32 v119, v119
    s_nop 0
    v_pk_add_f32 v[116:117], v[116:117], v[130:131]
    v_pk_add_f32 v[118:119], v[118:119], v[130:131]
    v_rcp_f32 v116, v116
    v_rcp_f32 v117, v117
    v_rcp_f32 v118, v118
    v_rcp_f32 v119, v119
    s_nop 0
    v_pk_mul_f32 v[116:117], v[116:117], v[156:157]
    v_pk_mul_f32 v[118:119], v[118:119], v[158:159]
    v_cvt_pk_bf16_f32 v126, v116, v117
    v_cvt_pk_bf16_f32 v127, v118, v119
    s_mov_b32 s20, 0
    buffer_store_dwordx2 v[120:121], v237, s[24:27], s20 offen sc1
    s_mov_b32 s20, 8192
    buffer_store_dwordx2 v[122:123], v237, s[24:27], s20 offen sc1
    s_mov_b32 s20, 16384
    buffer_store_dwordx2 v[124:125], v237, s[24:27], s20 offen sc1
    s_mov_b32 s20, 24576
    buffer_store_dwordx2 v[126:127], v237, s[24:27], s20 offen sc1
    s_waitcnt vmcnt(0)
    s_mov_b64 exec, 1
    buffer_store_dword v244, v248, s[32:35], 0 offen sc1
    s_mov_b64 exec, -1
    s_cmp_ge_u32 s9, 3
    s_cbranch_scc1 fin_d
    s_waitcnt vmcnt(0)
    s_mov_b32 s36, 100000
    s_cmp_lg_u32 s9, 0
    s_cbranch_scc1 fin_l
    buffer_load_dwordx4 v[112:115], v220, s[56:59], 0 offen sc1
    buffer_load_dwordx4 v[116:119], v221, s[56:59], 0 offen sc1
    buffer_load_dwordx4 v[120:123], v222, s[56:59], 0 offen sc1
    buffer_load_dwordx4 v[124:127], v223, s[56:59], 0 offen sc1
    buffer_load_dwordx4 v[128:131], v224, s[56:59], 0 offen sc1
    buffer_load_dwordx4 v[132:135], v225, s[56:59], 0 offen sc1
    buffer_load_dwordx4 v[136:139], v226, s[56:59], 0 offen sc1
    buffer_load_dwordx4 v[140:143], v227, s[56:59], 0 offen sc1
fin_l:
    s_call_b64 s[100:101], ev_sub
    s_mov_b32 s20, 40
    fin_b:
    s_sub_u32 s20, s20, 1
    s_cbranch_scc0 fin_b
    s_sub_u32 s36, s36, 1
    s_cbranch_scc1 fin_d
    s_cmp_lt_u32 s9, 3
    s_cbranch_scc1 fin_l
fin_d:
    s_waitcnt lgkmcnt(0)
    s_barrier
    ds_read_b128 v[48:51], v180 offset:0
    ds_read_b64_tr_b16 v[52:53], v194 offset:0
    ds_read_b64_tr_b16 v[54:55], v194 offset:256
    ds_read_b128 v[56:59], v181 offset:0
    ds_read_b64_tr_b16 v[60:61], v194 offset:1024
    ds_read_b64_tr_b16 v[62:63], v194 offset:1280
    ds_read_b128 v[64:67], v182 offset:0
    ds_read_b64_tr_b16 v[68:69], v194 offset:2048
    ds_read_b64_tr_b16 v[70:71], v194 offset:2304
    ds_read_b128 v[72:75], v183 offset:0
    ds_read_b64_tr_b16 v[76:77], v194 offset:3072
    ds_read_b64_tr_b16 v[78:79], v194 offset:3328
    ds_read_b128 v[80:83], v180 offset:16384
    ds_read_b64_tr_b16 v[84:85], v194 offset:16384
    ds_read_b64_tr_b16 v[86:87], v194 offset:16640
    s_waitcnt lgkmcnt(9)
    v_mfma_f32_32x32x16_bf16 v[160:175], v[48:51], v[52:55], 0
    ds_read_b128 v[88:91], v181 offset:16384
    ds_read_b64_tr_b16 v[92:93], v194 offset:17408
    ds_read_b64_tr_b16 v[94:95], v194 offset:17664
    v_mfma_f32_32x32x16_bf16 v[160:175], v[56:59], v[60:63], v[160:175]
    ds_read_b128 v[96:99], v182 offset:16384
    ds_read_b64_tr_b16 v[100:101], v194 offset:18432
    ds_read_b64_tr_b16 v[102:103], v194 offset:18688
    s_waitcnt lgkmcnt(9)
    v_mfma_f32_32x32x16_bf16 v[160:175], v[64:67], v[68:71], v[160:175]
    ds_read_b128 v[104:107], v183 offset:16384
    ds_read_b64_tr_b16 v[108:109], v194 offset:19456
    ds_read_b64_tr_b16 v[110:111], v194 offset:19712
    v_mfma_f32_32x32x16_bf16 v[160:175], v[72:75], v[76:79], v[160:175]
    s_mov_b32 s11, 1
    s_call_b64 s[38:39], a2_sub1
    s_mov_b32 s24, s96
    s_mov_b32 s25, s97
    s_mov_b32 s26, 4194304
    s_mov_b32 s27, 0x00020000
    s_mov_b32 s28, s94
    s_mov_b32 s29, s95
    s_mov_b32 s30, 4096
    s_mov_b32 s31, 0x00020000
    s_lshl_b32 s22, s55, 6
    s_lshl_b32 s20, s52, 7
    s_add_u32 s22, s22, s20
    v_lshl_add_u32 v6, v3, 1, s22
    buffer_load_ushort v238, v6, s[28:31], 0 offen
    s_lshl_b32 s22, s22, 10
    s_lshl_b32 s23, s54, 7
    s_lshl_b32 s20, s51, 8
    s_add_u32 s23, s23, s20
    s_add_u32 s22, s22, s23
    v_lshrrev_b32 v6, 3, v1
    v_and_b32 v9, 7, v1
    v_lshlrev_b32 v9, 4, v9
    v_lshl_add_u32 v237, v6, 11, v9
    v_add_u32 v237, s22, v237
    s_lshl_b32 s20, s3, 13
    s_add_u32 s20, s20, 8192
    v_mul_u32_u24 v6, 144, v6
    v_add3_u32 v239, v6, v9, s20
    v_mul_u32_u24 v6, 144, v3
    v_lshlrev_b32 v9, 4, v7
    v_add3_u32 v236, v6, v9, s20
    v_bfe_u32 v6, v3, 1, 3
    s_lshl_b32 s20, s54, 2
    v_xor_b32 v6, s20, v6
    v_lshlrev_b32 v6, 4, v6
    v_lshl_add_u32 v6, v3, 7, v6
    v_lshl_add_u32 v6, v7, 3, v6
    s_lshl_b32 s20, s55, 12
    s_add_u32 s20, s20, 8192
    v_add_u32 v220, s20, v6
    v_xor_b32 v221, 16, v220
    v_xor_b32 v222, 32, v220
    v_xor_b32 v223, 48, v220
    s_mov_b32 s11, 4
    s_call_b64 s[38:39], a2_sub3
    s_waitcnt lgkmcnt(0)
    s_barrier
    ds_read_b64 v[24:25], v220
    ds_read_b64 v[16:17], v220 offset:8192
    v_mfma_f32_32x32x16_bf16 v[160:175], v[80:83], v[84:87], v[160:175]
    ds_read_b64 v[26:27], v221
    ds_read_b64 v[18:19], v221 offset:8192
    v_mfma_f32_32x32x16_bf16 v[160:175], v[88:91], v[92:95], v[160:175]
    ds_read_b64 v[28:29], v222
    ds_read_b64 v[20:21], v222 offset:8192
    v_mfma_f32_32x32x16_bf16 v[160:175], v[96:99], v[100:103], v[160:175]
    ds_read_b64 v[30:31], v223
    ds_read_b64 v[22:23], v223 offset:8192
    v_mfma_f32_32x32x16_bf16 v[160:175], v[104:107], v[108:111], v[160:175]
    s_waitcnt lgkmcnt(0)
    s_barrier
    ds_read_b128 v[48:51], v176 offset:32768
    ds_read_b64_tr_b16 v[52:53], v178 offset:32768
    ds_read_b64_tr_b16 v[54:55], v178 offset:33280
    ds_read_b128 v[56:59], v176 offset:34816
    ds_read_b64_tr_b16 v[60:61], v178 offset:34816
    ds_read_b64_tr_b16 v[62:63], v178 offset:35328
    ds_read_b128 v[64:67], v176 offset:36864
    ds_read_b64_tr_b16 v[68:69], v178 offset:36864
    ds_read_b64_tr_b16 v[70:71], v178 offset:37376
    ds_read_b128 v[72:75], v176 offset:38912
    ds_read_b64_tr_b16 v[76:77], v178 offset:38912
    ds_read_b64_tr_b16 v[78:79], v178 offset:39424
    ds_read_b128 v[80:83], v176 offset:49152
    ds_read_b64_tr_b16 v[84:85], v178 offset:49152
    ds_read_b64_tr_b16 v[86:87], v178 offset:49664
    s_waitcnt lgkmcnt(9)
    v_mfma_f32_32x32x16_bf16 v[144:159], v[48:51], v[52:55], 0
    ds_read_b128 v[88:91], v176 offset:51200
    ds_read_b64_tr_b16 v[92:93], v178 offset:51200
    ds_read_b64_tr_b16 v[94:95], v178 offset:51712
    v_mfma_f32_32x32x16_bf16 v[144:159], v[56:59], v[60:63], v[144:159]
    ds_read_b128 v[96:99], v176 offset:53248
    ds_read_b64_tr_b16 v[100:101], v178 offset:53248
    ds_read_b64_tr_b16 v[102:103], v178 offset:53760
    s_waitcnt lgkmcnt(9)
    v_mfma_f32_32x32x16_bf16 v[144:159], v[64:67], v[68:71], v[144:159]
    ds_read_b128 v[104:107], v176 offset:55296
    ds_read_b64_tr_b16 v[108:109], v178 offset:55296
    ds_read_b64_tr_b16 v[110:111], v178 offset:55808
    v_mfma_f32_32x32x16_bf16 v[144:159], v[72:75], v[76:79], v[144:159]
    v_lshlrev_b32 v112, 16, v24
    v_and_b32 v113, 0xffff0000, v24
    v_add_f32 v160, v160, v112
    v_add_f32 v161, v161, v113
    v_lshlrev_b32 v32, 16, v16
    v_and_b32 v33, 0xffff0000, v16
    v_lshlrev_b32 v112, 16, v25
    v_and_b32 v113, 0xffff0000, v25
    v_add_f32 v162, v162, v112
    v_add_f32 v163, v163, v113
    v_lshlrev_b32 v34, 16, v17
    v_and_b32 v35, 0xffff0000, v17
    v_lshlrev_b32 v112, 16, v26
    v_and_b32 v113, 0xffff0000, v26
    v_add_f32 v164, v164, v112
    v_add_f32 v165, v165, v113
    v_lshlrev_b32 v36, 16, v18
    v_and_b32 v37, 0xffff0000, v18
    v_lshlrev_b32 v112, 16, v27
    v_and_b32 v113, 0xffff0000, v27
    v_add_f32 v166, v166, v112
    v_add_f32 v167, v167, v113
    v_lshlrev_b32 v38, 16, v19
    v_and_b32 v39, 0xffff0000, v19
    v_lshlrev_b32 v112, 16, v28
    v_and_b32 v113, 0xffff0000, v28
    v_add_f32 v168, v168, v112
    v_add_f32 v169, v169, v113
    v_lshlrev_b32 v40, 16, v20
    v_and_b32 v41, 0xffff0000, v20
    v_lshlrev_b32 v112, 16, v29
    v_and_b32 v113, 0xffff0000, v29
    v_add_f32 v170, v170, v112
    v_add_f32 v171, v171, v113
    v_lshlrev_b32 v42, 16, v21
    v_and_b32 v43, 0xffff0000, v21
    v_lshlrev_b32 v112, 16, v30
    v_and_b32 v113, 0xffff0000, v30
    v_add_f32 v172, v172, v112
    v_add_f32 v173, v173, v113
    v_lshlrev_b32 v44, 16, v22
    v_and_b32 v45, 0xffff0000, v22
    v_lshlrev_b32 v112, 16, v31
    v_and_b32 v113, 0xffff0000, v31
    v_add_f32 v174, v174, v112
    v_add_f32 v175, v175, v113
    v_lshlrev_b32 v46, 16, v23
    v_and_b32 v47, 0xffff0000, v23
    s_waitcnt vmcnt(0)
    v_lshlrev_b32 v8, 16, v238
    s_mov_b32 s22, 0xbfb8aa3b
    v_mov_b32 v9, v8
    v_mov_b32 v128, s22
    v_mov_b32 v129, s22
    v_mov_b32 v130, 1.0
    v_mov_b32 v131, 1.0
    s_mov_b32 s11, 9
    s_call_b64 s[38:39], ub_sub2
    s_waitcnt lgkmcnt(6)
    v_mfma_f32_32x32x16_bf16 v[144:159], v[80:83], v[84:87], v[144:159]
    v_mfma_f32_32x32x16_bf16 v[144:159], v[88:91], v[92:95], v[144:159]
    s_waitcnt lgkmcnt(0)
    v_mfma_f32_32x32x16_bf16 v[144:159], v[96:99], v[100:103], v[144:159]
    v_mfma_f32_32x32x16_bf16 v[144:159], v[104:107], v[108:111], v[144:159]
    s_nop 7
    s_nop 7
    v_cvt_pk_bf16_f32 v12, v144, v145
    v_lshlrev_b32 v144, 16, v12
    v_and_b32 v145, 0xffff0000, v12
    v_cvt_pk_bf16_f32 v13, v146, v147
    v_lshlrev_b32 v146, 16, v13
    v_and_b32 v147, 0xffff0000, v13
    v_pk_add_f32 v[144:145], v[144:145], v[8:9]
    v_pk_add_f32 v[146:147], v[146:147], v[8:9]
    v_cvt_pk_bf16_f32 v12, v144, v145
    v_lshlrev_b32 v144, 16, v12
    v_and_b32 v145, 0xffff0000, v12
    v_cvt_pk_bf16_f32 v13, v146, v147
    v_lshlrev_b32 v146, 16, v13
    v_and_b32 v147, 0xffff0000, v13
    v_pk_mul_f32 v[112:113], v[144:145], v[128:129]
    v_pk_mul_f32 v[114:115], v[146:147], v[128:129]
    v_exp_f32 v112, v112
    v_exp_f32 v113, v113
    v_exp_f32 v114, v114
    v_exp_f32 v115, v115
    s_nop 0
    v_pk_add_f32 v[112:113], v[112:113], v[130:131]
    v_pk_add_f32 v[114:115], v[114:115], v[130:131]
    v_rcp_f32 v112, v112
    v_rcp_f32 v113, v113
    v_rcp_f32 v114, v114
    v_rcp_f32 v115, v115
    s_nop 0
    v_pk_mul_f32 v[112:113], v[112:113], v[144:145]
    v_pk_mul_f32 v[114:115], v[114:115], v[146:147]
    v_cvt_pk_bf16_f32 v12, v112, v113
    v_lshlrev_b32 v112, 16, v12
    v_and_b32 v113, 0xffff0000, v12
    v_cvt_pk_bf16_f32 v13, v114, v115
    v_lshlrev_b32 v114, 16, v13
    v_and_b32 v115, 0xffff0000, v13
    v_pk_mul_f32 v[160:161], v[160:161], v[112:113]
    v_pk_mul_f32 v[162:163], v[162:163], v[114:115]
    v_pk_add_f32 v[160:161], v[160:161], v[32:33]
    v_pk_add_f32 v[162:163], v[162:163], v[34:35]
    ds_write_b128 v236, v[160:163] offset:0
    v_cvt_pk_bf16_f32 v12, v148, v149
    v_lshlrev_b32 v148, 16, v12
    v_and_b32 v149, 0xffff0000, v12
    v_cvt_pk_bf16_f32 v13, v150, v151
    v_lshlrev_b32 v150, 16, v13
    v_and_b32 v151, 0xffff0000, v13
    v_pk_add_f32 v[148:149], v[148:149], v[8:9]
    v_pk_add_f32 v[150:151], v[150:151], v[8:9]
    v_cvt_pk_bf16_f32 v12, v148, v149
    v_lshlrev_b32 v148, 16, v12
    v_and_b32 v149, 0xffff0000, v12
    v_cvt_pk_bf16_f32 v13, v150, v151
    v_lshlrev_b32 v150, 16, v13
    v_and_b32 v151, 0xffff0000, v13
    v_pk_mul_f32 v[112:113], v[148:149], v[128:129]
    v_pk_mul_f32 v[114:115], v[150:151], v[128:129]
    v_exp_f32 v112, v112
    v_exp_f32 v113, v113
    v_exp_f32 v114, v114
    v_exp_f32 v115, v115
    s_nop 0
    v_pk_add_f32 v[112:113], v[112:113], v[130:131]
    v_pk_add_f32 v[114:115], v[114:115], v[130:131]
    v_rcp_f32 v112, v112
    v_rcp_f32 v113, v113
    v_rcp_f32 v114, v114
    v_rcp_f32 v115, v115
    s_nop 0
    v_pk_mul_f32 v[112:113], v[112:113], v[148:149]
    v_pk_mul_f32 v[114:115], v[114:115], v[150:151]
    v_cvt_pk_bf16_f32 v12, v112, v113
    v_lshlrev_b32 v112, 16, v12
    v_and_b32 v113, 0xffff0000, v12
    v_cvt_pk_bf16_f32 v13, v114, v115
    v_lshlrev_b32 v114, 16, v13
    v_and_b32 v115, 0xffff0000, v13
    v_pk_mul_f32 v[164:165], v[164:165], v[112:113]
    v_pk_mul_f32 v[166:167], v[166:167], v[114:115]
    v_pk_add_f32 v[164:165], v[164:165], v[36:37]
    v_pk_add_f32 v[166:167], v[166:167], v[38:39]
    ds_write_b128 v236, v[164:167] offset:32
    v_cvt_pk_bf16_f32 v12, v152, v153
    v_lshlrev_b32 v152, 16, v12
    v_and_b32 v153, 0xffff0000, v12
    v_cvt_pk_bf16_f32 v13, v154, v155
    v_lshlrev_b32 v154, 16, v13
    v_and_b32 v155, 0xffff0000, v13
    v_pk_add_f32 v[152:153], v[152:153], v[8:9]
    v_pk_add_f32 v[154:155], v[154:155], v[8:9]
    v_cvt_pk_bf16_f32 v12, v152, v153
    v_lshlrev_b32 v152, 16, v12
    v_and_b32 v153, 0xffff0000, v12
    v_cvt_pk_bf16_f32 v13, v154, v155
    v_lshlrev_b32 v154, 16, v13
    v_and_b32 v155, 0xffff0000, v13
    v_pk_mul_f32 v[112:113], v[152:153], v[128:129]
    v_pk_mul_f32 v[114:115], v[154:155], v[128:129]
    v_exp_f32 v112, v112
    v_exp_f32 v113, v113
    v_exp_f32 v114, v114
    v_exp_f32 v115, v115
    s_nop 0
    v_pk_add_f32 v[112:113], v[112:113], v[130:131]
    v_pk_add_f32 v[114:115], v[114:115], v[130:131]
    v_rcp_f32 v112, v112
    v_rcp_f32 v113, v113
    v_rcp_f32 v114, v114
    v_rcp_f32 v115, v115
    s_nop 0
    v_pk_mul_f32 v[112:113], v[112:113], v[152:153]
    v_pk_mul_f32 v[114:115], v[114:115], v[154:155]
    v_cvt_pk_bf16_f32 v12, v112, v113
    v_lshlrev_b32 v112, 16, v12
    v_and_b32 v113, 0xffff0000, v12
    v_cvt_pk_bf16_f32 v13, v114, v115
    v_lshlrev_b32 v114, 16, v13
    v_and_b32 v115, 0xffff0000, v13
    v_pk_mul_f32 v[168:169], v[168:169], v[112:113]
    v_pk_mul_f32 v[170:171], v[170:171], v[114:115]
    v_pk_add_f32 v[168:169], v[168:169], v[40:41]
    v_pk_add_f32 v[170:171], v[170:171], v[42:43]
    ds_write_b128 v236, v[168:171] offset:64
    v_cvt_pk_bf16_f32 v12, v156, v157
    v_lshlrev_b32 v156, 16, v12
    v_and_b32 v157, 0xffff0000, v12
    v_cvt_pk_bf16_f32 v13, v158, v159
    v_lshlrev_b32 v158, 16, v13
    v_and_b32 v159, 0xffff0000, v13
    v_pk_add_f32 v[156:157], v[156:157], v[8:9]
    v_pk_add_f32 v[158:159], v[158:159], v[8:9]
    v_cvt_pk_bf16_f32 v12, v156, v157
    v_lshlrev_b32 v156, 16, v12
    v_and_b32 v157, 0xffff0000, v12
    v_cvt_pk_bf16_f32 v13, v158, v159
    v_lshlrev_b32 v158, 16, v13
    v_and_b32 v159, 0xffff0000, v13
    v_pk_mul_f32 v[112:113], v[156:157], v[128:129]
    v_pk_mul_f32 v[114:115], v[158:159], v[128:129]
    v_exp_f32 v112, v112
    v_exp_f32 v113, v113
    v_exp_f32 v114, v114
    v_exp_f32 v115, v115
    s_nop 0
    v_pk_add_f32 v[112:113], v[112:113], v[130:131]
    v_pk_add_f32 v[114:115], v[114:115], v[130:131]
    v_rcp_f32 v112, v112
    v_rcp_f32 v113, v113
    v_rcp_f32 v114, v114
    v_rcp_f32 v115, v115
    s_nop 0
    v_pk_mul_f32 v[112:113], v[112:113], v[156:157]
    v_pk_mul_f32 v[114:115], v[114:115], v[158:159]
    v_cvt_pk_bf16_f32 v12, v112, v113
    v_lshlrev_b32 v112, 16, v12
    v_and_b32 v113, 0xffff0000, v12
    v_cvt_pk_bf16_f32 v13, v114, v115
    v_lshlrev_b32 v114, 16, v13
    v_and_b32 v115, 0xffff0000, v13
    v_pk_mul_f32 v[172:173], v[172:173], v[112:113]
    v_pk_mul_f32 v[174:175], v[174:175], v[114:115]
    v_pk_add_f32 v[172:173], v[172:173], v[44:45]
    v_pk_add_f32 v[174:175], v[174:175], v[46:47]
    ds_write_b128 v236, v[172:175] offset:96
    ds_read_b128 v[48:51], v239 offset:0
    s_mov_b32 s20, 0
    ds_read_b128 v[52:55], v239 offset:1152
    s_mov_b32 s21, 16384
    ds_read_b128 v[56:59], v239 offset:2304
    s_mov_b32 s22, 32768
    ds_read_b128 v[60:63], v239 offset:3456
    s_mov_b32 s23, 49152
    s_waitcnt lgkmcnt(3)
    buffer_store_dwordx4 v[48:51], v237, s[24:27], s20 offen sc1
    s_waitcnt lgkmcnt(2)
    buffer_store_dwordx4 v[52:55], v237, s[24:27], s21 offen sc1
    s_waitcnt lgkmcnt(1)
    buffer_store_dwordx4 v[56:59], v237, s[24:27], s22 offen sc1
    s_waitcnt lgkmcnt(0)
    buffer_store_dwordx4 v[60:63], v237, s[24:27], s23 offen sc1
    s_endpgm
ev_sub:
    s_cmp_eq_u32 s9, 0
    s_cbranch_scc1 ev_0
    s_add_u32 s9, s9, 1
    s_cmp_eq_u32 s9, 2
    s_cbranch_scc1 ev_r
    s_waitcnt vmcnt(0)
    s_mov_b64 exec, 1
    buffer_store_dword v244, v246, s[32:35], 0 offen sc1
    s_mov_b64 exec, -1
    s_mov_b32 s60, s78
    s_mov_b32 s61, s79
    s_mov_b32 s62, 524288
    s_mov_b32 s63, 0x00020000
    s_mov_b32 s64, s80
    s_mov_b32 s65, s81
    s_mov_b32 s66, 524288
    s_mov_b32 s67, 0x00020000
    s_mov_b32 s56, s92
    s_mov_b32 s57, s93
    s_mov_b32 s58, 5636096
    s_mov_b32 s59, 0x00020000
    s_cmp_lt_u32 s19, 22
    s_cbranch_scc1 c_nopf
    s_sub_u32 s20, s19, 22
    s_lshl_b32 s20, s20, 8
    v_add_u32 v6, s20, v0
    v_lshlrev_b32 v9, 7, v6
    s_mov_b32 s21, 327680
    buffer_load_dword v199, v9, s[60:63], 0 offen
    buffer_load_dword v199, v9, s[64:67], 0 offen
    buffer_load_dword v199, v9, s[60:63], s21 offen
    buffer_load_dword v199, v9, s[64:67], s21 offen
    v_lshrrev_b32 v9, 2, v6
    v_lshlrev_b32 v9, 12, v9
    v_and_b32 v6, 3, v6
    v_lshl_add_u32 v9, v6, 7, v9
    s_lshl_b32 s20, s18, 9
c_nopf:
ev_r:
    s_setpc_b64 s[100:101]
ev_0:
    s_waitcnt vmcnt(0)
    v_cmp_ne_u32 s[20:21], v114, v228
    v_cmp_ne_u32 vcc, v118, v229
    s_or_b64 s[20:21], s[20:21], vcc
    v_cmp_ne_u32 vcc, v122, v230
    s_or_b64 s[20:21], s[20:21], vcc
    v_cmp_ne_u32 vcc, v126, v231
    s_or_b64 s[20:21], s[20:21], vcc
    v_cmp_ne_u32 vcc, v130, v232
    s_or_b64 s[20:21], s[20:21], vcc
    v_cmp_ne_u32 vcc, v134, v233
    s_or_b64 s[20:21], s[20:21], vcc
    v_cmp_ne_u32 vcc, v138, v234
    s_or_b64 s[20:21], s[20:21], vcc
    v_cmp_ne_u32 vcc, v142, v235
    s_or_b64 s[20:21], s[20:21], vcc
    s_cmp_eq_u64 s[20:21], 0
    s_cbranch_scc1 ev_p2
    buffer_load_dwordx4 v[112:115], v220, s[56:59], 0 offen sc1
    buffer_load_dwordx4 v[116:119], v221, s[56:59], 0 offen sc1
    buffer_load_dwordx4 v[120:123], v222, s[56:59], 0 offen sc1
    buffer_load_dwordx4 v[124:127], v223, s[56:59], 0 offen sc1
    buffer_load_dwordx4 v[128:131], v224, s[56:59], 0 offen sc1
    buffer_load_dwordx4 v[132:135], v225, s[56:59], 0 offen sc1
    buffer_load_dwordx4 v[136:139], v226, s[56:59], 0 offen sc1
    buffer_load_dwordx4 v[140:143], v227, s[56:59], 0 offen sc1
    s_setpc_b64 s[100:101]
ev_p2:
    v_fma_f32 v52, v214, v140, v136
    v_fma_f32 v53, v214, v141, v137
    v_fma_f32 v52, -v215, v141, v52
    v_fma_f32 v53, v215, v140, v53
    v_fma_f32 v54, v214, v52, v132
    v_fma_f32 v55, v214, v53, v133
    v_fma_f32 v54, -v215, v53, v54
    v_fma_f32 v55, v215, v52, v55
    v_fma_f32 v52, v214, v54, v128
    v_fma_f32 v53, v214, v55, v129
    v_fma_f32 v52, -v215, v55, v52
    v_fma_f32 v53, v215, v54, v53
    v_fma_f32 v54, v214, v52, v124
    v_fma_f32 v55, v214, v53, v125
    v_fma_f32 v54, -v215, v53, v54
    v_fma_f32 v55, v215, v52, v55
    v_fma_f32 v52, v214, v54, v120
    v_fma_f32 v53, v214, v55, v121
    v_fma_f32 v52, -v215, v55, v52
    v_fma_f32 v53, v215, v54, v53
    v_fma_f32 v54, v214, v52, v116
    v_fma_f32 v55, v214, v53, v117
    v_fma_f32 v54, -v215, v53, v54
    v_fma_f32 v55, v215, v52, v55
    v_fma_f32 v52, v214, v54, v112
    v_fma_f32 v53, v214, v55, v113
    v_fma_f32 v52, -v215, v55, v52
    v_fma_f32 v53, v215, v54, v53
    s_add_u32 s24, s16, 4194304
    s_addc_u32 s25, s17, 0
    s_mov_b32 s26, 4194304
    s_mov_b32 s27, 0x00020000
    v_mov_b32 v56, v52
    v_mov_b32 v57, v53
    s_lshl_b32 s20, s12, 8
    v_lshlrev_b32 v13, 11, v4
    v_permlane32_swap_b32 v52, v56
    v_permlane32_swap_b32 v53, v57
    v_lshl_add_u32 v13, v8, 5, v13
    v_add_u32 v13, s20, v13
    v_add_u32 v12, 2097152, v13
    s_lshl_b32 s20, s12, 2
    s_add_u32 s20, s20, s3
    s_lshl_b32 s20, s20, 16
    v_lshrrev_b32 v13, 3, v4
    v_lshlrev_b32 v13, 8, v13
    v_and_b32 v12, 6, v4
    v_lshl_add_u32 v13, v12, 3, v13
    v_lshl_add_u32 v13, v7, 7, v13
    v_add_u32 v13, s20, v13
    v_add_u32 v12, 32768, v13
    v_fma_f32 v58, v212, v56, v52
    v_fma_f32 v59, v212, v57, v53
    v_fma_f32 v58, -v213, v57, v58
    v_fma_f32 v59, v213, v56, v59
    v_fma_f32 v54, v208, v58, v216
    v_fma_f32 v55, v208, v59, v217
    v_fma_f32 v54, -v209, v59, v54
    v_fma_f32 v55, v209, v58, v55
    v_mul_f32 v52, v210, v54
    v_mul_f32 v53, v210, v55
    v_fma_f32 v52, -v211, v55, v52
    v_fma_f32 v53, v211, v54, v53
    v_fma_f32 v16, v204, v52, v16
    v_fma_f32 v32, v204, v53, v32
    v_fma_f32 v16, -v205, v53, v16
    v_fma_f32 v32, v205, v52, v32
    v_fma_f32 v17, v204, v16, v17
    v_fma_f32 v33, v204, v32, v33
    v_fma_f32 v17, -v205, v32, v17
    v_fma_f32 v33, v205, v16, v33
    v_cvt_pk_bf16_f32 v112, v16, v17
    v_cvt_pk_bf16_f32 v120, -v32, -v33
    v_fma_f32 v18, v204, v17, v18
    v_fma_f32 v34, v204, v33, v34
    v_fma_f32 v18, -v205, v33, v18
    v_fma_f32 v34, v205, v17, v34
    v_fma_f32 v19, v204, v18, v19
    v_fma_f32 v35, v204, v34, v35
    v_fma_f32 v19, -v205, v34, v19
    v_fma_f32 v35, v205, v18, v35
    v_cvt_pk_bf16_f32 v113, v18, v19
    v_cvt_pk_bf16_f32 v121, -v34, -v35
    v_fma_f32 v20, v204, v19, v20
    v_fma_f32 v36, v204, v35, v36
    v_fma_f32 v20, -v205, v35, v20
    v_fma_f32 v36, v205, v19, v36
    v_fma_f32 v21, v204, v20, v21
    v_fma_f32 v37, v204, v36, v37
    v_fma_f32 v21, -v205, v36, v21
    v_fma_f32 v37, v205, v20, v37
    v_cvt_pk_bf16_f32 v114, v20, v21
    v_cvt_pk_bf16_f32 v122, -v36, -v37
    v_fma_f32 v22, v204, v21, v22
    v_fma_f32 v38, v204, v37, v38
    v_fma_f32 v22, -v205, v37, v22
    v_fma_f32 v38, v205, v21, v38
    v_fma_f32 v23, v204, v22, v23
    v_fma_f32 v39, v204, v38, v39
    v_fma_f32 v23, -v205, v38, v23
    v_fma_f32 v39, v205, v22, v39
    v_cvt_pk_bf16_f32 v115, v22, v23
    v_cvt_pk_bf16_f32 v123, -v38, -v39
    buffer_store_dwordx4 v[112:115], v13, s[24:27], 0 offen sc1
    buffer_store_dwordx4 v[120:123], v12, s[24:27], 0 offen sc1
    v_fma_f32 v24, v204, v23, v24
    v_fma_f32 v40, v204, v39, v40
    v_fma_f32 v24, -v205, v39, v24
    v_fma_f32 v40, v205, v23, v40
    v_fma_f32 v25, v204, v24, v25
    v_fma_f32 v41, v204, v40, v41
    v_fma_f32 v25, -v205, v40, v25
    v_fma_f32 v41, v205, v24, v41
    v_cvt_pk_bf16_f32 v116, v24, v25
    v_cvt_pk_bf16_f32 v124, -v40, -v41
    v_fma_f32 v26, v204, v25, v26
    v_fma_f32 v42, v204, v41, v42
    v_fma_f32 v26, -v205, v41, v26
    v_fma_f32 v42, v205, v25, v42
    v_fma_f32 v27, v204, v26, v27
    v_fma_f32 v43, v204, v42, v43
    v_fma_f32 v27, -v205, v42, v27
    v_fma_f32 v43, v205, v26, v43
    v_cvt_pk_bf16_f32 v117, v26, v27
    v_cvt_pk_bf16_f32 v125, -v42, -v43
    v_fma_f32 v28, v204, v27, v28
    v_fma_f32 v44, v204, v43, v44
    v_fma_f32 v28, -v205, v43, v28
    v_fma_f32 v44, v205, v27, v44
    v_fma_f32 v29, v204, v28, v29
    v_fma_f32 v45, v204, v44, v45
    v_fma_f32 v29, -v205, v44, v29
    v_fma_f32 v45, v205, v28, v45
    v_cvt_pk_bf16_f32 v118, v28, v29
    v_cvt_pk_bf16_f32 v126, -v44, -v45
    v_fma_f32 v30, v204, v29, v30
    v_fma_f32 v46, v204, v45, v46
    v_fma_f32 v30, -v205, v45, v30
    v_fma_f32 v46, v205, v29, v46
    v_fma_f32 v31, v204, v30, v31
    v_fma_f32 v47, v204, v46, v47
    v_fma_f32 v31, -v205, v46, v31
    v_fma_f32 v47, v205, v30, v47
    v_cvt_pk_bf16_f32 v119, v30, v31
    v_cvt_pk_bf16_f32 v127, -v46, -v47
    buffer_store_dwordx4 v[116:119], v13, s[24:27], 0 offen offset:64 sc1
    buffer_store_dwordx4 v[124:127], v12, s[24:27], 0 offen offset:64 sc1
    s_mov_b32 s9, 1
    s_setpc_b64 s[100:101]
.p2align 6
kk_sub0:
    s_waitcnt lgkmcnt(0)
    s_barrier
    ds_read_b64_tr_b16 v[48:49], v176 offset:0
    ds_read_b64_tr_b16 v[50:51], v176 offset:512
    ds_read_b64_tr_b16 v[52:53], v178 offset:0
    ds_read_b64_tr_b16 v[54:55], v178 offset:512
    v_mfma_f32_32x32x16_bf16 v[144:159], v[84:87], v[80:83], v[144:159]
    ds_read_b64_tr_b16 v[56:57], v176 offset:2048
    ds_read_b64_tr_b16 v[58:59], v176 offset:2560
    ds_read_b64_tr_b16 v[60:61], v178 offset:2048
    ds_read_b64_tr_b16 v[62:63], v178 offset:2560
    v_mfma_f32_32x32x16_bf16 v[144:159], v[92:95], v[88:91], v[144:159]
    ds_read_b64_tr_b16 v[64:65], v176 offset:4096
    ds_read_b64_tr_b16 v[66:67], v176 offset:4608
    ds_read_b64_tr_b16 v[68:69], v178 offset:4096
    ds_read_b64_tr_b16 v[70:71], v178 offset:4608
    v_mfma_f32_32x32x16_bf16 v[144:159], v[100:103], v[96:99], v[144:159]
    ds_read_b64_tr_b16 v[72:73], v176 offset:6144
    ds_read_b64_tr_b16 v[74:75], v176 offset:6656
    ds_read_b64_tr_b16 v[76:77], v178 offset:6144
    ds_read_b64_tr_b16 v[78:79], v178 offset:6656
    v_mfma_f32_32x32x16_bf16 v[144:159], v[108:111], v[104:107], v[144:159]
    ds_read_b64_tr_b16 v[80:81], v176 offset:16384
    ds_read_b64_tr_b16 v[82:83], v176 offset:16896
    ds_read_b64_tr_b16 v[84:85], v178 offset:16384
    ds_read_b64_tr_b16 v[86:87], v178 offset:16896
    s_waitcnt lgkmcnt(12)
    v_mfma_f32_32x32x16_bf16 v[144:159], v[52:55], v[48:51], v[144:159]
    ds_read_b64_tr_b16 v[88:89], v176 offset:18432
    ds_read_b64_tr_b16 v[90:91], v176 offset:18944
    ds_read_b64_tr_b16 v[92:93], v178 offset:18432
    ds_read_b64_tr_b16 v[94:95], v178 offset:18944
    v_mfma_f32_32x32x16_bf16 v[144:159], v[60:63], v[56:59], v[144:159]
    ds_read_b64_tr_b16 v[96:97], v176 offset:20480
    ds_read_b64_tr_b16 v[98:99], v176 offset:20992
    ds_read_b64_tr_b16 v[100:101], v178 offset:20480
    ds_read_b64_tr_b16 v[102:103], v178 offset:20992
    s_waitcnt lgkmcnt(12)
    v_mfma_f32_32x32x16_bf16 v[144:159], v[68:71], v[64:67], v[144:159]
    ds_read_b64_tr_b16 v[104:105], v176 offset:22528
    ds_read_b64_tr_b16 v[106:107], v176 offset:23040
    ds_read_b64_tr_b16 v[108:109], v178 offset:22528
    ds_read_b64_tr_b16 v[110:111], v178 offset:23040
    v_mfma_f32_32x32x16_bf16 v[144:159], v[76:79], v[72:75], v[144:159]
    s_sub_u32 s11, s11, 1
    s_cbranch_scc1 kk_sub_r
kk_sub1:
    s_waitcnt lgkmcnt(0)
    s_barrier
    ds_read_b64_tr_b16 v[48:49], v176 offset:32768
    ds_read_b64_tr_b16 v[50:51], v176 offset:33280
    ds_read_b64_tr_b16 v[52:53], v178 offset:32768
    ds_read_b64_tr_b16 v[54:55], v178 offset:33280
    v_mfma_f32_32x32x16_bf16 v[144:159], v[84:87], v[80:83], v[144:159]
    ds_read_b64_tr_b16 v[56:57], v176 offset:34816
    ds_read_b64_tr_b16 v[58:59], v176 offset:35328
    ds_read_b64_tr_b16 v[60:61], v178 offset:34816
    ds_read_b64_tr_b16 v[62:63], v178 offset:35328
    v_mfma_f32_32x32x16_bf16 v[144:159], v[92:95], v[88:91], v[144:159]
    ds_read_b64_tr_b16 v[64:65], v176 offset:36864
    ds_read_b64_tr_b16 v[66:67], v176 offset:37376
    ds_read_b64_tr_b16 v[68:69], v178 offset:36864
    ds_read_b64_tr_b16 v[70:71], v178 offset:37376
    v_mfma_f32_32x32x16_bf16 v[144:159], v[100:103], v[96:99], v[144:159]
    ds_read_b64_tr_b16 v[72:73], v176 offset:38912
    ds_read_b64_tr_b16 v[74:75], v176 offset:39424
    ds_read_b64_tr_b16 v[76:77], v178 offset:38912
    ds_read_b64_tr_b16 v[78:79], v178 offset:39424
    v_mfma_f32_32x32x16_bf16 v[144:159], v[108:111], v[104:107], v[144:159]
    ds_read_b64_tr_b16 v[80:81], v176 offset:49152
    ds_read_b64_tr_b16 v[82:83], v176 offset:49664
    ds_read_b64_tr_b16 v[84:85], v178 offset:49152
    ds_read_b64_tr_b16 v[86:87], v178 offset:49664
    s_waitcnt lgkmcnt(12)
    v_mfma_f32_32x32x16_bf16 v[144:159], v[52:55], v[48:51], v[144:159]
    ds_read_b64_tr_b16 v[88:89], v176 offset:51200
    ds_read_b64_tr_b16 v[90:91], v176 offset:51712
    ds_read_b64_tr_b16 v[92:93], v178 offset:51200
    ds_read_b64_tr_b16 v[94:95], v178 offset:51712
    v_mfma_f32_32x32x16_bf16 v[144:159], v[60:63], v[56:59], v[144:159]
    ds_read_b64_tr_b16 v[96:97], v176 offset:53248
    ds_read_b64_tr_b16 v[98:99], v176 offset:53760
    ds_read_b64_tr_b16 v[100:101], v178 offset:53248
    ds_read_b64_tr_b16 v[102:103], v178 offset:53760
    s_waitcnt lgkmcnt(12)
    v_mfma_f32_32x32x16_bf16 v[144:159], v[68:71], v[64:67], v[144:159]
    ds_read_b64_tr_b16 v[104:105], v176 offset:55296
    ds_read_b64_tr_b16 v[106:107], v176 offset:55808
    ds_read_b64_tr_b16 v[108:109], v178 offset:55296
    ds_read_b64_tr_b16 v[110:111], v178 offset:55808
    v_mfma_f32_32x32x16_bf16 v[144:159], v[76:79], v[72:75], v[144:159]
    s_sub_u32 s11, s11, 1
    s_cbranch_scc1 kk_sub_r
kk_sub2:
    s_waitcnt lgkmcnt(0)
    s_barrier
    ds_read_b64_tr_b16 v[48:49], v177 offset:0
    ds_read_b64_tr_b16 v[50:51], v177 offset:512
    ds_read_b64_tr_b16 v[52:53], v179 offset:0
    ds_read_b64_tr_b16 v[54:55], v179 offset:512
    v_mfma_f32_32x32x16_bf16 v[144:159], v[84:87], v[80:83], v[144:159]
    ds_read_b64_tr_b16 v[56:57], v177 offset:2048
    ds_read_b64_tr_b16 v[58:59], v177 offset:2560
    ds_read_b64_tr_b16 v[60:61], v179 offset:2048
    ds_read_b64_tr_b16 v[62:63], v179 offset:2560
    v_mfma_f32_32x32x16_bf16 v[144:159], v[92:95], v[88:91], v[144:159]
    ds_read_b64_tr_b16 v[64:65], v177 offset:4096
    ds_read_b64_tr_b16 v[66:67], v177 offset:4608
    ds_read_b64_tr_b16 v[68:69], v179 offset:4096
    ds_read_b64_tr_b16 v[70:71], v179 offset:4608
    v_mfma_f32_32x32x16_bf16 v[144:159], v[100:103], v[96:99], v[144:159]
    ds_read_b64_tr_b16 v[72:73], v177 offset:6144
    ds_read_b64_tr_b16 v[74:75], v177 offset:6656
    ds_read_b64_tr_b16 v[76:77], v179 offset:6144
    ds_read_b64_tr_b16 v[78:79], v179 offset:6656
    v_mfma_f32_32x32x16_bf16 v[144:159], v[108:111], v[104:107], v[144:159]
    ds_read_b64_tr_b16 v[80:81], v177 offset:16384
    ds_read_b64_tr_b16 v[82:83], v177 offset:16896
    ds_read_b64_tr_b16 v[84:85], v179 offset:16384
    ds_read_b64_tr_b16 v[86:87], v179 offset:16896
    s_waitcnt lgkmcnt(12)
    v_mfma_f32_32x32x16_bf16 v[144:159], v[52:55], v[48:51], v[144:159]
    ds_read_b64_tr_b16 v[88:89], v177 offset:18432
    ds_read_b64_tr_b16 v[90:91], v177 offset:18944
    ds_read_b64_tr_b16 v[92:93], v179 offset:18432
    ds_read_b64_tr_b16 v[94:95], v179 offset:18944
    v_mfma_f32_32x32x16_bf16 v[144:159], v[60:63], v[56:59], v[144:159]
    ds_read_b64_tr_b16 v[96:97], v177 offset:20480
    ds_read_b64_tr_b16 v[98:99], v177 offset:20992
    ds_read_b64_tr_b16 v[100:101], v179 offset:20480
    ds_read_b64_tr_b16 v[102:103], v179 offset:20992
    s_waitcnt lgkmcnt(12)
    v_mfma_f32_32x32x16_bf16 v[144:159], v[68:71], v[64:67], v[144:159]
    ds_read_b64_tr_b16 v[104:105], v177 offset:22528
    ds_read_b64_tr_b16 v[106:107], v177 offset:23040
    ds_read_b64_tr_b16 v[108:109], v179 offset:22528
    ds_read_b64_tr_b16 v[110:111], v179 offset:23040
    v_mfma_f32_32x32x16_bf16 v[144:159], v[76:79], v[72:75], v[144:159]
    s_sub_u32 s11, s11, 1
    s_cbranch_scc1 kk_sub_r
kk_sub3:
    s_waitcnt lgkmcnt(0)
    s_barrier
    ds_read_b64_tr_b16 v[48:49], v177 offset:32768
    ds_read_b64_tr_b16 v[50:51], v177 offset:33280
    ds_read_b64_tr_b16 v[52:53], v179 offset:32768
    ds_read_b64_tr_b16 v[54:55], v179 offset:33280
    v_mfma_f32_32x32x16_bf16 v[144:159], v[84:87], v[80:83], v[144:159]
    ds_read_b64_tr_b16 v[56:57], v177 offset:34816
    ds_read_b64_tr_b16 v[58:59], v177 offset:35328
    ds_read_b64_tr_b16 v[60:61], v179 offset:34816
    ds_read_b64_tr_b16 v[62:63], v179 offset:35328
    v_mfma_f32_32x32x16_bf16 v[144:159], v[92:95], v[88:91], v[144:159]
    ds_read_b64_tr_b16 v[64:65], v177 offset:36864
    ds_read_b64_tr_b16 v[66:67], v177 offset:37376
    ds_read_b64_tr_b16 v[68:69], v179 offset:36864
    ds_read_b64_tr_b16 v[70:71], v179 offset:37376
    v_mfma_f32_32x32x16_bf16 v[144:159], v[100:103], v[96:99], v[144:159]
    ds_read_b64_tr_b16 v[72:73], v177 offset:38912
    ds_read_b64_tr_b16 v[74:75], v177 offset:39424
    ds_read_b64_tr_b16 v[76:77], v179 offset:38912
    ds_read_b64_tr_b16 v[78:79], v179 offset:39424
    v_mfma_f32_32x32x16_bf16 v[144:159], v[108:111], v[104:107], v[144:159]
    ds_read_b64_tr_b16 v[80:81], v177 offset:49152
    ds_read_b64_tr_b16 v[82:83], v177 offset:49664
    ds_read_b64_tr_b16 v[84:85], v179 offset:49152
    ds_read_b64_tr_b16 v[86:87], v179 offset:49664
    s_waitcnt lgkmcnt(12)
    v_mfma_f32_32x32x16_bf16 v[144:159], v[52:55], v[48:51], v[144:159]
    ds_read_b64_tr_b16 v[88:89], v177 offset:51200
    ds_read_b64_tr_b16 v[90:91], v177 offset:51712
    ds_read_b64_tr_b16 v[92:93], v179 offset:51200
    ds_read_b64_tr_b16 v[94:95], v179 offset:51712
    v_mfma_f32_32x32x16_bf16 v[144:159], v[60:63], v[56:59], v[144:159]
    ds_read_b64_tr_b16 v[96:97], v177 offset:53248
    ds_read_b64_tr_b16 v[98:99], v177 offset:53760
    ds_read_b64_tr_b16 v[100:101], v179 offset:53248
    ds_read_b64_tr_b16 v[102:103], v179 offset:53760
    s_waitcnt lgkmcnt(12)
    v_mfma_f32_32x32x16_bf16 v[144:159], v[68:71], v[64:67], v[144:159]
    ds_read_b64_tr_b16 v[104:105], v177 offset:55296
    ds_read_b64_tr_b16 v[106:107], v177 offset:55808
    ds_read_b64_tr_b16 v[108:109], v179 offset:55296
    ds_read_b64_tr_b16 v[110:111], v179 offset:55808
    v_mfma_f32_32x32x16_bf16 v[144:159], v[76:79], v[72:75], v[144:159]
    s_sub_u32 s11, s11, 1
    s_cbranch_scc0 kk_sub0
kk_sub_r:
    s_setpc_b64 s[38:39]
.p2align 6
a2_sub0:
    s_waitcnt lgkmcnt(0)
    s_barrier
    ds_read_b128 v[48:51], v180 offset:0
    ds_read_b64_tr_b16 v[52:53], v194 offset:0
    ds_read_b64_tr_b16 v[54:55], v194 offset:256
    v_mfma_f32_32x32x16_bf16 v[160:175], v[80:83], v[84:87], v[160:175]
    ds_read_b128 v[56:59], v181 offset:0
    ds_read_b64_tr_b16 v[60:61], v194 offset:1024
    ds_read_b64_tr_b16 v[62:63], v194 offset:1280
    v_mfma_f32_32x32x16_bf16 v[160:175], v[88:91], v[92:95], v[160:175]
    ds_read_b128 v[64:67], v182 offset:0
    ds_read_b64_tr_b16 v[68:69], v194 offset:2048
    ds_read_b64_tr_b16 v[70:71], v194 offset:2304
    v_mfma_f32_32x32x16_bf16 v[160:175], v[96:99], v[100:103], v[160:175]
    ds_read_b128 v[72:75], v183 offset:0
    ds_read_b64_tr_b16 v[76:77], v194 offset:3072
    ds_read_b64_tr_b16 v[78:79], v194 offset:3328
    v_mfma_f32_32x32x16_bf16 v[160:175], v[104:107], v[108:111], v[160:175]
    ds_read_b128 v[80:83], v180 offset:16384
    ds_read_b64_tr_b16 v[84:85], v194 offset:16384
    ds_read_b64_tr_b16 v[86:87], v194 offset:16640
    s_waitcnt lgkmcnt(9)
    v_mfma_f32_32x32x16_bf16 v[160:175], v[48:51], v[52:55], v[160:175]
    ds_read_b128 v[88:91], v181 offset:16384
    ds_read_b64_tr_b16 v[92:93], v194 offset:17408
    ds_read_b64_tr_b16 v[94:95], v194 offset:17664
    v_mfma_f32_32x32x16_bf16 v[160:175], v[56:59], v[60:63], v[160:175]
    ds_read_b128 v[96:99], v182 offset:16384
    ds_read_b64_tr_b16 v[100:101], v194 offset:18432
    ds_read_b64_tr_b16 v[102:103], v194 offset:18688
    s_waitcnt lgkmcnt(9)
    v_mfma_f32_32x32x16_bf16 v[160:175], v[64:67], v[68:71], v[160:175]
    ds_read_b128 v[104:107], v183 offset:16384
    ds_read_b64_tr_b16 v[108:109], v194 offset:19456
    ds_read_b64_tr_b16 v[110:111], v194 offset:19712
    v_mfma_f32_32x32x16_bf16 v[160:175], v[72:75], v[76:79], v[160:175]
    s_sub_u32 s11, s11, 1
    s_cbranch_scc1 a2_sub_r
a2_sub1:
    s_waitcnt lgkmcnt(0)
    s_barrier
    ds_read_b128 v[48:51], v180 offset:32768
    ds_read_b64_tr_b16 v[52:53], v194 offset:32768
    ds_read_b64_tr_b16 v[54:55], v194 offset:33024
    v_mfma_f32_32x32x16_bf16 v[160:175], v[80:83], v[84:87], v[160:175]
    ds_read_b128 v[56:59], v181 offset:32768
    ds_read_b64_tr_b16 v[60:61], v194 offset:33792
    ds_read_b64_tr_b16 v[62:63], v194 offset:34048
    v_mfma_f32_32x32x16_bf16 v[160:175], v[88:91], v[92:95], v[160:175]
    ds_read_b128 v[64:67], v182 offset:32768
    ds_read_b64_tr_b16 v[68:69], v194 offset:34816
    ds_read_b64_tr_b16 v[70:71], v194 offset:35072
    v_mfma_f32_32x32x16_bf16 v[160:175], v[96:99], v[100:103], v[160:175]
    ds_read_b128 v[72:75], v183 offset:32768
    ds_read_b64_tr_b16 v[76:77], v194 offset:35840
    ds_read_b64_tr_b16 v[78:79], v194 offset:36096
    v_mfma_f32_32x32x16_bf16 v[160:175], v[104:107], v[108:111], v[160:175]
    ds_read_b128 v[80:83], v180 offset:49152
    ds_read_b64_tr_b16 v[84:85], v194 offset:49152
    ds_read_b64_tr_b16 v[86:87], v194 offset:49408
    s_waitcnt lgkmcnt(9)
    v_mfma_f32_32x32x16_bf16 v[160:175], v[48:51], v[52:55], v[160:175]
    ds_read_b128 v[88:91], v181 offset:49152
    ds_read_b64_tr_b16 v[92:93], v194 offset:50176
    ds_read_b64_tr_b16 v[94:95], v194 offset:50432
    v_mfma_f32_32x32x16_bf16 v[160:175], v[56:59], v[60:63], v[160:175]
    ds_read_b128 v[96:99], v182 offset:49152
    ds_read_b64_tr_b16 v[100:101], v194 offset:51200
    ds_read_b64_tr_b16 v[102:103], v194 offset:51456
    s_waitcnt lgkmcnt(9)
    v_mfma_f32_32x32x16_bf16 v[160:175], v[64:67], v[68:71], v[160:175]
    ds_read_b128 v[104:107], v183 offset:49152
    ds_read_b64_tr_b16 v[108:109], v194 offset:52224
    ds_read_b64_tr_b16 v[110:111], v194 offset:52480
    v_mfma_f32_32x32x16_bf16 v[160:175], v[72:75], v[76:79], v[160:175]
    s_sub_u32 s11, s11, 1
    s_cbranch_scc1 a2_sub_r
a2_sub2:
    s_waitcnt lgkmcnt(0)
    s_barrier
    ds_read_b128 v[48:51], v184 offset:0
    ds_read_b64_tr_b16 v[52:53], v195 offset:0
    ds_read_b64_tr_b16 v[54:55], v195 offset:256
    v_mfma_f32_32x32x16_bf16 v[160:175], v[80:83], v[84:87], v[160:175]
    ds_read_b128 v[56:59], v185 offset:0
    ds_read_b64_tr_b16 v[60:61], v195 offset:1024
    ds_read_b64_tr_b16 v[62:63], v195 offset:1280
    v_mfma_f32_32x32x16_bf16 v[160:175], v[88:91], v[92:95], v[160:175]
    ds_read_b128 v[64:67], v186 offset:0
    ds_read_b64_tr_b16 v[68:69], v195 offset:2048
    ds_read_b64_tr_b16 v[70:71], v195 offset:2304
    v_mfma_f32_32x32x16_bf16 v[160:175], v[96:99], v[100:103], v[160:175]
    ds_read_b128 v[72:75], v187 offset:0
    ds_read_b64_tr_b16 v[76:77], v195 offset:3072
    ds_read_b64_tr_b16 v[78:79], v195 offset:3328
    v_mfma_f32_32x32x16_bf16 v[160:175], v[104:107], v[108:111], v[160:175]
    ds_read_b128 v[80:83], v184 offset:16384
    ds_read_b64_tr_b16 v[84:85], v195 offset:16384
    ds_read_b64_tr_b16 v[86:87], v195 offset:16640
    s_waitcnt lgkmcnt(9)
    v_mfma_f32_32x32x16_bf16 v[160:175], v[48:51], v[52:55], v[160:175]
    ds_read_b128 v[88:91], v185 offset:16384
    ds_read_b64_tr_b16 v[92:93], v195 offset:17408
    ds_read_b64_tr_b16 v[94:95], v195 offset:17664
    v_mfma_f32_32x32x16_bf16 v[160:175], v[56:59], v[60:63], v[160:175]
    ds_read_b128 v[96:99], v186 offset:16384
    ds_read_b64_tr_b16 v[100:101], v195 offset:18432
    ds_read_b64_tr_b16 v[102:103], v195 offset:18688
    s_waitcnt lgkmcnt(9)
    v_mfma_f32_32x32x16_bf16 v[160:175], v[64:67], v[68:71], v[160:175]
    ds_read_b128 v[104:107], v187 offset:16384
    ds_read_b64_tr_b16 v[108:109], v195 offset:19456
    ds_read_b64_tr_b16 v[110:111], v195 offset:19712
    v_mfma_f32_32x32x16_bf16 v[160:175], v[72:75], v[76:79], v[160:175]
    s_sub_u32 s11, s11, 1
    s_cbranch_scc1 a2_sub_r
a2_sub3:
    s_waitcnt lgkmcnt(0)
    s_barrier
    ds_read_b128 v[48:51], v184 offset:32768
    ds_read_b64_tr_b16 v[52:53], v195 offset:32768
    ds_read_b64_tr_b16 v[54:55], v195 offset:33024
    v_mfma_f32_32x32x16_bf16 v[160:175], v[80:83], v[84:87], v[160:175]
    ds_read_b128 v[56:59], v185 offset:32768
    ds_read_b64_tr_b16 v[60:61], v195 offset:33792
    ds_read_b64_tr_b16 v[62:63], v195 offset:34048
    v_mfma_f32_32x32x16_bf16 v[160:175], v[88:91], v[92:95], v[160:175]
    ds_read_b128 v[64:67], v186 offset:32768
    ds_read_b64_tr_b16 v[68:69], v195 offset:34816
    ds_read_b64_tr_b16 v[70:71], v195 offset:35072
    v_mfma_f32_32x32x16_bf16 v[160:175], v[96:99], v[100:103], v[160:175]
    ds_read_b128 v[72:75], v187 offset:32768
    ds_read_b64_tr_b16 v[76:77], v195 offset:35840
    ds_read_b64_tr_b16 v[78:79], v195 offset:36096
    v_mfma_f32_32x32x16_bf16 v[160:175], v[104:107], v[108:111], v[160:175]
    ds_read_b128 v[80:83], v184 offset:49152
    ds_read_b64_tr_b16 v[84:85], v195 offset:49152
    ds_read_b64_tr_b16 v[86:87], v195 offset:49408
    s_waitcnt lgkmcnt(9)
    v_mfma_f32_32x32x16_bf16 v[160:175], v[48:51], v[52:55], v[160:175]
    ds_read_b128 v[88:91], v185 offset:49152
    ds_read_b64_tr_b16 v[92:93], v195 offset:50176
    ds_read_b64_tr_b16 v[94:95], v195 offset:50432
    v_mfma_f32_32x32x16_bf16 v[160:175], v[56:59], v[60:63], v[160:175]
    ds_read_b128 v[96:99], v186 offset:49152
    ds_read_b64_tr_b16 v[100:101], v195 offset:51200
    ds_read_b64_tr_b16 v[102:103], v195 offset:51456
    s_waitcnt lgkmcnt(9)
    v_mfma_f32_32x32x16_bf16 v[160:175], v[64:67], v[68:71], v[160:175]
    ds_read_b128 v[104:107], v187 offset:49152
    ds_read_b64_tr_b16 v[108:109], v195 offset:52224
    ds_read_b64_tr_b16 v[110:111], v195 offset:52480
    v_mfma_f32_32x32x16_bf16 v[160:175], v[72:75], v[76:79], v[160:175]
    s_sub_u32 s11, s11, 1
    s_cbranch_scc0 a2_sub0
a2_sub_r:
    s_setpc_b64 s[38:39]
.p2align 6
ub_sub0:
    s_waitcnt lgkmcnt(0)
    s_barrier
    ds_read_b128 v[48:51], v176 offset:0
    ds_read_b64_tr_b16 v[52:53], v178 offset:0
    ds_read_b64_tr_b16 v[54:55], v178 offset:512
    v_mfma_f32_32x32x16_bf16 v[144:159], v[80:83], v[84:87], v[144:159]
    ds_read_b128 v[56:59], v176 offset:2048
    ds_read_b64_tr_b16 v[60:61], v178 offset:2048
    ds_read_b64_tr_b16 v[62:63], v178 offset:2560
    v_mfma_f32_32x32x16_bf16 v[144:159], v[88:91], v[92:95], v[144:159]
    ds_read_b128 v[64:67], v176 offset:4096
    ds_read_b64_tr_b16 v[68:69], v178 offset:4096
    ds_read_b64_tr_b16 v[70:71], v178 offset:4608
    v_mfma_f32_32x32x16_bf16 v[144:159], v[96:99], v[100:103], v[144:159]
    ds_read_b128 v[72:75], v176 offset:6144
    ds_read_b64_tr_b16 v[76:77], v178 offset:6144
    ds_read_b64_tr_b16 v[78:79], v178 offset:6656
    v_mfma_f32_32x32x16_bf16 v[144:159], v[104:107], v[108:111], v[144:159]
    ds_read_b128 v[80:83], v176 offset:16384
    ds_read_b64_tr_b16 v[84:85], v178 offset:16384
    ds_read_b64_tr_b16 v[86:87], v178 offset:16896
    s_waitcnt lgkmcnt(9)
    v_mfma_f32_32x32x16_bf16 v[144:159], v[48:51], v[52:55], v[144:159]
    ds_read_b128 v[88:91], v176 offset:18432
    ds_read_b64_tr_b16 v[92:93], v178 offset:18432
    ds_read_b64_tr_b16 v[94:95], v178 offset:18944
    v_mfma_f32_32x32x16_bf16 v[144:159], v[56:59], v[60:63], v[144:159]
    ds_read_b128 v[96:99], v176 offset:20480
    ds_read_b64_tr_b16 v[100:101], v178 offset:20480
    ds_read_b64_tr_b16 v[102:103], v178 offset:20992
    s_waitcnt lgkmcnt(9)
    v_mfma_f32_32x32x16_bf16 v[144:159], v[64:67], v[68:71], v[144:159]
    ds_read_b128 v[104:107], v176 offset:22528
    ds_read_b64_tr_b16 v[108:109], v178 offset:22528
    ds_read_b64_tr_b16 v[110:111], v178 offset:23040
    v_mfma_f32_32x32x16_bf16 v[144:159], v[72:75], v[76:79], v[144:159]
    s_sub_u32 s11, s11, 1
    s_cbranch_scc1 ub_sub_r
ub_sub1:
    s_waitcnt lgkmcnt(0)
    s_barrier
    ds_read_b128 v[48:51], v176 offset:32768
    ds_read_b64_tr_b16 v[52:53], v178 offset:32768
    ds_read_b64_tr_b16 v[54:55], v178 offset:33280
    v_mfma_f32_32x32x16_bf16 v[144:159], v[80:83], v[84:87], v[144:159]
    ds_read_b128 v[56:59], v176 offset:34816
    ds_read_b64_tr_b16 v[60:61], v178 offset:34816
    ds_read_b64_tr_b16 v[62:63], v178 offset:35328
    v_mfma_f32_32x32x16_bf16 v[144:159], v[88:91], v[92:95], v[144:159]
    ds_read_b128 v[64:67], v176 offset:36864
    ds_read_b64_tr_b16 v[68:69], v178 offset:36864
    ds_read_b64_tr_b16 v[70:71], v178 offset:37376
    v_mfma_f32_32x32x16_bf16 v[144:159], v[96:99], v[100:103], v[144:159]
    ds_read_b128 v[72:75], v176 offset:38912
    ds_read_b64_tr_b16 v[76:77], v178 offset:38912
    ds_read_b64_tr_b16 v[78:79], v178 offset:39424
    v_mfma_f32_32x32x16_bf16 v[144:159], v[104:107], v[108:111], v[144:159]
    ds_read_b128 v[80:83], v176 offset:49152
    ds_read_b64_tr_b16 v[84:85], v178 offset:49152
    ds_read_b64_tr_b16 v[86:87], v178 offset:49664
    s_waitcnt lgkmcnt(9)
    v_mfma_f32_32x32x16_bf16 v[144:159], v[48:51], v[52:55], v[144:159]
    ds_read_b128 v[88:91], v176 offset:51200
    ds_read_b64_tr_b16 v[92:93], v178 offset:51200
    ds_read_b64_tr_b16 v[94:95], v178 offset:51712
    v_mfma_f32_32x32x16_bf16 v[144:159], v[56:59], v[60:63], v[144:159]
    ds_read_b128 v[96:99], v176 offset:53248
    ds_read_b64_tr_b16 v[100:101], v178 offset:53248
    ds_read_b64_tr_b16 v[102:103], v178 offset:53760
    s_waitcnt lgkmcnt(9)
    v_mfma_f32_32x32x16_bf16 v[144:159], v[64:67], v[68:71], v[144:159]
    ds_read_b128 v[104:107], v176 offset:55296
    ds_read_b64_tr_b16 v[108:109], v178 offset:55296
    ds_read_b64_tr_b16 v[110:111], v178 offset:55808
    v_mfma_f32_32x32x16_bf16 v[144:159], v[72:75], v[76:79], v[144:159]
    s_sub_u32 s11, s11, 1
    s_cbranch_scc1 ub_sub_r
ub_sub2:
    s_waitcnt lgkmcnt(0)
    s_barrier
    ds_read_b128 v[48:51], v177 offset:0
    ds_read_b64_tr_b16 v[52:53], v179 offset:0
    ds_read_b64_tr_b16 v[54:55], v179 offset:512
    v_mfma_f32_32x32x16_bf16 v[144:159], v[80:83], v[84:87], v[144:159]
    ds_read_b128 v[56:59], v177 offset:2048
    ds_read_b64_tr_b16 v[60:61], v179 offset:2048
    ds_read_b64_tr_b16 v[62:63], v179 offset:2560
    v_mfma_f32_32x32x16_bf16 v[144:159], v[88:91], v[92:95], v[144:159]
    ds_read_b128 v[64:67], v177 offset:4096
    ds_read_b64_tr_b16 v[68:69], v179 offset:4096
    ds_read_b64_tr_b16 v[70:71], v179 offset:4608
    v_mfma_f32_32x32x16_bf16 v[144:159], v[96:99], v[100:103], v[144:159]
    ds_read_b128 v[72:75], v177 offset:6144
    ds_read_b64_tr_b16 v[76:77], v179 offset:6144
    ds_read_b64_tr_b16 v[78:79], v179 offset:6656
    v_mfma_f32_32x32x16_bf16 v[144:159], v[104:107], v[108:111], v[144:159]
    ds_read_b128 v[80:83], v177 offset:16384
    ds_read_b64_tr_b16 v[84:85], v179 offset:16384
    ds_read_b64_tr_b16 v[86:87], v179 offset:16896
    s_waitcnt lgkmcnt(9)
    v_mfma_f32_32x32x16_bf16 v[144:159], v[48:51], v[52:55], v[144:159]
    ds_read_b128 v[88:91], v177 offset:18432
    ds_read_b64_tr_b16 v[92:93], v179 offset:18432
    ds_read_b64_tr_b16 v[94:95], v179 offset:18944
    v_mfma_f32_32x32x16_bf16 v[144:159], v[56:59], v[60:63], v[144:159]
    ds_read_b128 v[96:99], v177 offset:20480
    ds_read_b64_tr_b16 v[100:101], v179 offset:20480
    ds_read_b64_tr_b16 v[102:103], v179 offset:20992
    s_waitcnt lgkmcnt(9)
    v_mfma_f32_32x32x16_bf16 v[144:159], v[64:67], v[68:71], v[144:159]
    ds_read_b128 v[104:107], v177 offset:22528
    ds_read_b64_tr_b16 v[108:109], v179 offset:22528
    ds_read_b64_tr_b16 v[110:111], v179 offset:23040
    v_mfma_f32_32x32x16_bf16 v[144:159], v[72:75], v[76:79], v[144:159]
    s_sub_u32 s11, s11, 1
    s_cbranch_scc1 ub_sub_r
ub_sub3:
    s_waitcnt lgkmcnt(0)
    s_barrier
    ds_read_b128 v[48:51], v177 offset:32768
    ds_read_b64_tr_b16 v[52:53], v179 offset:32768
    ds_read_b64_tr_b16 v[54:55], v179 offset:33280
    v_mfma_f32_32x32x16_bf16 v[144:159], v[80:83], v[84:87], v[144:159]
    ds_read_b128 v[56:59], v177 offset:34816
    ds_read_b64_tr_b16 v[60:61], v179 offset:34816
    ds_read_b64_tr_b16 v[62:63], v179 offset:35328
    v_mfma_f32_32x32x16_bf16 v[144:159], v[88:91], v[92:95], v[144:159]
    ds_read_b128 v[64:67], v177 offset:36864
    ds_read_b64_tr_b16 v[68:69], v179 offset:36864
    ds_read_b64_tr_b16 v[70:71], v179 offset:37376
    v_mfma_f32_32x32x16_bf16 v[144:159], v[96:99], v[100:103], v[144:159]
    ds_read_b128 v[72:75], v177 offset:38912
    ds_read_b64_tr_b16 v[76:77], v179 offset:38912
    ds_read_b64_tr_b16 v[78:79], v179 offset:39424
    v_mfma_f32_32x32x16_bf16 v[144:159], v[104:107], v[108:111], v[144:159]
    ds_read_b128 v[80:83], v177 offset:49152
    ds_read_b64_tr_b16 v[84:85], v179 offset:49152
    ds_read_b64_tr_b16 v[86:87], v179 offset:49664
    s_waitcnt lgkmcnt(9)
    v_mfma_f32_32x32x16_bf16 v[144:159], v[48:51], v[52:55], v[144:159]
    ds_read_b128 v[88:91], v177 offset:51200
    ds_read_b64_tr_b16 v[92:93], v179 offset:51200
    ds_read_b64_tr_b16 v[94:95], v179 offset:51712
    v_mfma_f32_32x32x16_bf16 v[144:159], v[56:59], v[60:63], v[144:159]
    ds_read_b128 v[96:99], v177 offset:53248
    ds_read_b64_tr_b16 v[100:101], v179 offset:53248
    ds_read_b64_tr_b16 v[102:103], v179 offset:53760
    s_waitcnt lgkmcnt(9)
    v_mfma_f32_32x32x16_bf16 v[144:159], v[64:67], v[68:71], v[144:159]
    ds_read_b128 v[104:107], v177 offset:55296
    ds_read_b64_tr_b16 v[108:109], v179 offset:55296
    ds_read_b64_tr_b16 v[110:111], v179 offset:55808
    v_mfma_f32_32x32x16_bf16 v[144:159], v[72:75], v[76:79], v[144:159]
    s_sub_u32 s11, s11, 1
    s_cbranch_scc0 ub_sub0
ub_sub_r:
    s_setpc_b64 s[38:39]
.p2align 6
loader:
    s_cmp_lt_u32 s19, 28
    s_cbranch_scc1 l_nopf
    s_getpc_b64 s[40:41]
    l_pc:
    s_sub_u32 s40, s40, l_pc-recurrent_scan__ssm_conv_s5__mixer_token_mlp__prompt_kernel
    s_subb_u32 s41, s41, 0
    v_and_b32 v50, 255, v0
    v_lshlrev_b32 v50, 7, v50
    v_min_u32 v50, k_end-recurrent_scan__ssm_conv_s5__mixer_token_mlp__prompt_kernel, v50
    global_load_dword v51, v50, s[40:41]
    l_nopf:
    s_sub_u32 s3, s3, 4
    v_lshrrev_b32 v6, 3, v1
    v_lshrrev_b32 v7, 4, v1
    v_and_b32 v8, 7, v1
    v_xor_b32 v7, v7, v8
    v_xor_b32 v17, 4, v7
    v_lshlrev_b32 v9, 10, v6
    v_lshl_add_u32 v16, v7, 4, v9
    v_lshl_add_u32 v17, v17, 4, v9
    v_add_u32 v17, 7168, v17
    s_lshl_b32 s20, s12, 17
    s_lshl_b32 s21, s3, 15
    s_add_u32 s20, s20, s21
    v_add_u32 v10, s20, v16
    v_add_u32 v11, s20, v17
    v_add_u32 v12, 14336, v10
    v_add_u32 v13, 14336, v11
    s_lshl_b32 s20, s13, 15
    s_and_b32 s54, s3, 1
    s_lshl_b32 s21, s54, 14
    s_add_u32 s20, s20, s21
    v_add_u32 v14, s20, v16
    v_add_u32 v15, s20, v17
    s_lshl_b32 s10, s3, 12
    s_lshl_b32 s21, s3, 11
    s_sub_u32 s37, 16384, s21
    s_add_u32 s10, s10, 8192
    s_mov_b32 s14, s10
    s_add_u32 s15, s10, 147456
    s_add_u32 s10, s10, 98304
    s_and_b32 s8, s19, 3
    s_lshl_b32 s8, s8, 1
    s_lshr_b32 s20, s19, 2
    s_add_u32 s8, s8, s20
    s_lshl_b32 s8, s8, 7
    s_and_b32 s8, s8, 1023
    s_mov_b32 s11, 6
    s_waitcnt lgkmcnt(0)
    s_mov_b32 s4, s68
    s_mov_b32 s5, s69
    s_mov_b32 s6, 2097152
    s_mov_b32 s7, 0x00020000
    s_add_u32 s64, s16, 14680064
    s_addc_u32 s65, s17, 0
    s_mov_b32 s66, 196608
    s_mov_b32 s67, 0x00020000
    v_mov_b32 v2, 0
    buffer_load_dword v244, v2, s[64:67], 0 offen sc1
    s_cmp_ge_u32 s3, 2
    s_cselect_b32 s32, s76, s74
    s_cselect_b32 s33, s77, s75
    s_mov_b32 s34, 524288
    s_mov_b32 s35, 0x00020000
l_pro:
    s_mov_b32 m0, s10
    s_add_u32 s38, s10, s37
    buffer_load_dwordx4 v10, s[4:7], s8 offen lds
    buffer_load_dwordx4 v11, s[4:7], s8 offen offset:1024 lds
    s_add_u32 s10, s10, 24576
    buffer_load_dwordx4 v12, s[4:7], s8 offen offset:2048 lds
    s_cmp_ge_u32 s10, s15
    buffer_load_dwordx4 v13, s[4:7], s8 offen offset:3072 lds
    s_mov_b32 m0, s38
    s_cselect_b32 s10, s14, s10
    buffer_load_dwordx4 v14, s[32:35], s8 offen lds
    buffer_load_dwordx4 v15, s[32:35], s8 offen offset:1024 lds
    s_add_u32 s8, s8, 128
    s_and_b32 s8, s8, 1023
    s_sub_u32 s11, s11, 1
    s_cmp_lg_u32 s11, 0
    s_cbranch_scc1 l_pro
    s_lshl_b32 s23, s54, 5
    v_add_u32 v6, s23, v6
    v_lshrrev_b32 v7, 2, v1
    v_and_b32 v7, 4, v7
    v_xor_b32 v7, v7, v8
    v_lshlrev_b32 v7, 4, v7
    s_lshl_b32 s20, s48, 2
    s_mul_i32 s21, s49, 11
    s_add_u32 s20, s20, s21
    s_and_b32 s56, s20, 31
    s_lshl_b32 s20, s51, 1
    s_lshl_b32 s21, s53, 2
    s_add_u32 s20, s20, s21
    s_and_b32 s57, s20, 15
    s_mul_i32 s20, s51, 3
    s_mul_i32 s21, s53, 6
    s_add_u32 s58, s20, s21
    s_cmp_ge_u32 s58, 22
    s_cselect_b32 s20, 22, 0
    s_sub_u32 s58, s58, s20
    s_lshl_b32 s56, s48, 2
    s_mul_i32 s58, s51, 3
    s_and_b32 s20, s53, 1
    s_mul_i32 s20, s20, 11
    s_add_u32 s58, s58, s20
    s_cmp_ge_u32 s58, 22
    s_cselect_b32 s20, 22, 0
    s_sub_u32 s58, s58, s20

    s_bitcmp1_b32 s3, 1
    s_cbranch_scc1 l_B
l_A:
    v_mul_u32_u24 v9, 128, v6
    s_lshl_b32 s20, s48, 18
    v_add3_u32 v20, v9, v7, s20
    v_add_u32 v21, 0, v20
    v_add_u32 v22, 0, v20
    v_add_u32 v23, 0, v20
    s_lshl_b32 s20, s51, 10
    s_lshl_b32 s21, s54, 15
    s_add_u32 s20, s20, s21
    v_lshl_add_u32 v28, v1, 4, s20
    v_add_u32 v29, 7168, v28
    v_add_u32 v30, 14336, v28
    v_add_u32 v31, 21504, v28
    s_lshl_b32 s20, s51, 16
    s_lshl_b32 s21, s54, 15
    s_add_u32 s20, s20, s21
    v_add_u32 v24, s20, v16
    v_add_u32 v25, s20, v17
    v_add_u32 v26, 14336, v24
    v_add_u32 v27, 14336, v25
    s_mov_b32 s24, s16
    s_mov_b32 s25, s17
    s_mov_b32 s26, 2097152
    s_mov_b32 s27, 0x00020000
    s_cmp_ge_u32 s57, 8
    s_cselect_b64 s[28:29], s[80:81], s[78:79]
    s_cselect_b64 s[22:23], s[78:79], s[80:81]
    s_mov_b32 s30, 524288
    s_mov_b32 s31, 0x00020000
    s_and_b32 s57, s57, 7
    s_add_u32 s60, s16, 8388608
    s_addc_u32 s61, s17, 0
    s_mov_b32 s62, 1409024
    s_mov_b32 s63, 0x00020000
    s_and_b32 s26, s26, s50
    v_and_b32 v2, 3, v1
    v_mul_u32_u24 v35, 260, v2
    s_lshl_b32 s20, s3, 8
    v_lshl_add_u32 v34, v1, 2, s20
    v_mov_b32 v32, 0
    s_mov_b32 s59, 0
    s_mov_b32 s55, 100000
    v_lshrrev_b32 v36, 2, v1
    v_lshlrev_b32 v36, 7, v36
    v_lshl_add_u32 v36, v2, 4, v36
    s_lshl_b32 s20, s18, 11
    s_add_u32 s20, s20, 4096
    v_add_u32 v36, s20, v36
    s_lshl_b32 s20, s51, 9
    s_add_u32 s20, s20, 28672
    v_min_u32 v2, 21, v1
    v_lshl_add_u32 v37, v2, 4, s20
    s_waitcnt vmcnt(24)
    s_barrier
    v_add_u32 v244, 0x9e3779b9, v244
    s_waitcnt vmcnt(12)
    s_barrier
    s_mov_b32 m0, s10
    s_add_u32 s38, s10, s37
    buffer_load_dwordx4 v10, s[4:7], s8 offen lds
    buffer_load_dwordx4 v11, s[4:7], s8 offen offset:1024 lds
    s_add_u32 s10, s10, 24576
    buffer_load_dwordx4 v12, s[4:7], s8 offen offset:2048 lds
    s_cmp_ge_u32 s10, s15
    buffer_load_dwordx4 v13, s[4:7], s8 offen offset:3072 lds
    s_mov_b32 m0, s38
    s_cselect_b32 s10, s14, s10
    buffer_load_dwordx4 v14, s[32:35], s8 offen lds
    buffer_load_dwordx4 v15, s[32:35], s8 offen offset:1024 lds
    s_add_u32 s8, s8, 128
    s_and_b32 s8, s8, 1023
    s_mov_b32 m0, s10
    s_add_u32 s38, s10, s37
    buffer_load_dwordx4 v10, s[4:7], s8 offen lds
    buffer_load_dwordx4 v11, s[4:7], s8 offen offset:1024 lds
    s_add_u32 s10, s10, 24576
    buffer_load_dwordx4 v12, s[4:7], s8 offen offset:2048 lds
    s_cmp_ge_u32 s10, s15
    buffer_load_dwordx4 v13, s[4:7], s8 offen offset:3072 lds
    s_mov_b32 m0, s38
    s_cselect_b32 s10, s14, s10
    buffer_load_dwordx4 v14, s[32:35], s8 offen lds
    buffer_load_dwordx4 v15, s[32:35], s8 offen offset:1024 lds
    s_add_u32 s8, s8, 128
    s_and_b32 s8, s8, 1023
    s_mov_b32 s10, s14
    s_add_u32 s15, s14, 131072
    s_mul_i32 s8, s56, 8192
    s_waitcnt vmcnt(12)
    s_barrier
    s_lshl_b32 s20, s12, 10
    s_add_u32 s20, s20, 32768
    v_lshl_add_u32 v44, v1, 4, s20
    s_mov_b32 m0, 0
    buffer_load_dwordx4 v44, s[64:67], 0 offen sc1 lds
    s_waitcnt vmcnt(1)
    s_barrier
    buffer_load_dwordx4 v[40:43], v36, s[64:67], 0 offen sc1
    s_waitcnt vmcnt(1)
    s_barrier
    s_lshl_b32 s20, s52, 16
    s_lshl_b32 s21, s54, 15
    s_add_u32 s20, s20, s21
    s_lshl_b32 s21, s51, 7
    s_add_u32 s20, s20, s21
    v_add_u32 v10, s20, v16
    v_add_u32 v11, s20, v17
    v_add_u32 v12, 14336, v10
    v_add_u32 v13, 14336, v11
    s_add_u32 s4, s16, 2097152
    s_addc_u32 s5, s17, 0
    s_mov_b32 s6, 2097152
    s_mov_b32 s7, 0x00020000
    s_cmp_eq_u32 s59, 1
    s_cbranch_scc1 l_hdone
    s_mov_b32 s36, 100000
pt_18:
    s_waitcnt vmcnt(0)
    v_cmp_ne_u32 s[20:21], v40, v244
    v_cmp_ne_u32 vcc, v41, v244
    s_or_b64 s[20:21], s[20:21], vcc
    v_cmp_ne_u32 vcc, v42, v244
    s_or_b64 s[20:21], s[20:21], vcc
    v_cmp_ne_u32 vcc, v43, v244
    s_or_b64 s[20:21], s[20:21], vcc
    s_cmp_eq_u64 s[20:21], 0
    s_cbranch_scc1 pd_17
    s_sub_u32 s36, s36, 1
    s_cbranch_scc1 pd_17
    s_mov_b32 s20, 40
dl_19:
    s_sub_u32 s20, s20, 1
    s_cbranch_scc0 dl_19
    buffer_load_dwordx4 v[40:43], v36, s[64:67], 0 offen sc1
    s_branch pt_18
pd_17:
    s_mov_b32 s11, 5
l_burst:
    s_mov_b32 m0, s10
    s_add_u32 s10, s10, 16384
    buffer_load_dwordx4 v20, s[24:27], s8 offen sc1 lds
    buffer_load_dwordx4 v21, s[24:27], s8 offen offset:1024 sc1 lds
    s_cmp_ge_u32 s10, s15
    buffer_load_dwordx4 v22, s[24:27], s8 offen offset:2048 sc1 lds
    s_cselect_b32 s10, s14, s10
    buffer_load_dwordx4 v23, s[24:27], s8 offen offset:3072 sc1 lds
    s_add_u32 s8, s8, 8192
    s_cmp_eq_u32 s8, 262144
    s_cselect_b32 s8, 0, s8
    s_sub_u32 s11, s11, 1
    s_cbranch_scc0 l_burst
l_hdone:
    s_mov_b32 s11, 12
ll_20:
    s_waitcnt vmcnt(16)
    s_barrier
    s_mov_b32 m0, s10
    s_add_u32 s10, s10, 16384
    buffer_load_dwordx4 v20, s[24:27], s8 offen sc1 lds
    buffer_load_dwordx4 v21, s[24:27], s8 offen offset:1024 sc1 lds
    s_cmp_ge_u32 s10, s15
    buffer_load_dwordx4 v22, s[24:27], s8 offen offset:2048 sc1 lds
    s_cselect_b32 s10, s14, s10
    buffer_load_dwordx4 v23, s[24:27], s8 offen offset:3072 sc1 lds
    s_add_u32 s8, s8, 8192
    s_cmp_eq_u32 s8, 262144
    s_cselect_b32 s8, 0, s8
    s_mov_b32 m0, s10
    s_add_u32 s10, s10, 16384
    buffer_load_dwordx4 v20, s[24:27], s8 offen sc1 lds
    buffer_load_dwordx4 v21, s[24:27], s8 offen offset:1024 sc1 lds
    s_cmp_ge_u32 s10, s15
    buffer_load_dwordx4 v22, s[24:27], s8 offen offset:2048 sc1 lds
    s_cselect_b32 s10, s14, s10
    buffer_load_dwordx4 v23, s[24:27], s8 offen offset:3072 sc1 lds
    s_add_u32 s8, s8, 8192
    s_cmp_eq_u32 s8, 262144
    s_cselect_b32 s8, 0, s8
    s_sub_u32 s11, s11, 1
    s_cbranch_scc0 ll_20
    s_mul_i32 s8, s57, 128
    s_mov_b32 s11, 6
ll_21:
    s_waitcnt vmcnt(16)
    s_barrier
    s_mov_b32 m0, s10
    s_add_u32 s10, s10, 16384
    buffer_load_dwordx4 v24, s[28:31], s8 offen lds
    buffer_load_dwordx4 v25, s[28:31], s8 offen offset:1024 lds
    s_cmp_ge_u32 s10, s15
    buffer_load_dwordx4 v26, s[28:31], s8 offen offset:2048 lds
    s_cselect_b32 s10, s14, s10
    buffer_load_dwordx4 v27, s[28:31], s8 offen offset:3072 lds
    s_add_u32 s8, s8, 128
    s_cmp_eq_u32 s8, 1024
    s_cselect_b32 s8, 0, s8
    s_mov_b64 s[20:21], s[28:29]
    s_cselect_b64 s[28:29], s[22:23], s[28:29]
    s_cselect_b64 s[22:23], s[20:21], s[22:23]
    s_mov_b32 m0, s10
    s_add_u32 s10, s10, 16384
    buffer_load_dwordx4 v24, s[28:31], s8 offen lds
    buffer_load_dwordx4 v25, s[28:31], s8 offen offset:1024 lds
    s_cmp_ge_u32 s10, s15
    buffer_load_dwordx4 v26, s[28:31], s8 offen offset:2048 lds
    s_cselect_b32 s10, s14, s10
    buffer_load_dwordx4 v27, s[28:31], s8 offen offset:3072 lds
    s_add_u32 s8, s8, 128
    s_cmp_eq_u32 s8, 1024
    s_cselect_b32 s8, 0, s8
    s_mov_b64 s[20:21], s[28:29]
    s_cselect_b64 s[28:29], s[22:23], s[28:29]
    s_cselect_b64 s[22:23], s[20:21], s[22:23]
    s_sub_u32 s11, s11, 1
    s_cbranch_scc0 ll_21
    s_cmp_lg_u32 s54, 0
    s_cbranch_scc1 lf_22
    buffer_load_dwordx4 v[40:43], v37, s[64:67], 0 offen sc1
lf_22:
    s_waitcnt vmcnt(16)
    s_barrier
    s_mov_b32 m0, s10
    s_add_u32 s10, s10, 16384
    buffer_load_dwordx4 v24, s[28:31], s8 offen lds
    buffer_load_dwordx4 v25, s[28:31], s8 offen offset:1024 lds
    s_cmp_ge_u32 s10, s15
    buffer_load_dwordx4 v26, s[28:31], s8 offen offset:2048 lds
    s_cselect_b32 s10, s14, s10
    buffer_load_dwordx4 v27, s[28:31], s8 offen offset:3072 lds
    s_add_u32 s8, s8, 128
    s_cmp_eq_u32 s8, 1024
    s_cselect_b32 s8, 0, s8
    s_mov_b64 s[20:21], s[28:29]
    s_cselect_b64 s[28:29], s[22:23], s[28:29]
    s_cselect_b64 s[22:23], s[20:21], s[22:23]
    s_mov_b32 m0, s10
    s_add_u32 s10, s10, 16384
    buffer_load_dwordx4 v24, s[28:31], s8 offen lds
    buffer_load_dwordx4 v25, s[28:31], s8 offen offset:1024 lds
    s_cmp_ge_u32 s10, s15
    buffer_load_dwordx4 v26, s[28:31], s8 offen offset:2048 lds
    s_cselect_b32 s10, s14, s10
    buffer_load_dwordx4 v27, s[28:31], s8 offen offset:3072 lds
    s_add_u32 s8, s8, 128
    s_cmp_eq_u32 s8, 1024
    s_cselect_b32 s8, 0, s8
    s_mov_b64 s[20:21], s[28:29]
    s_cselect_b64 s[28:29], s[22:23], s[28:29]
    s_cselect_b64 s[22:23], s[20:21], s[22:23]
    s_waitcnt vmcnt(16)
    s_barrier
    s_mov_b32 s8, 0
    s_mov_b32 m0, s10
    s_add_u32 s10, s10, 16384
    buffer_load_dwordx4 v10, s[4:7], s8 offen sc1 lds
    buffer_load_dwordx4 v11, s[4:7], s8 offen offset:1024 sc1 lds
    s_cmp_ge_u32 s10, s15
    buffer_load_dwordx4 v12, s[4:7], s8 offen offset:2048 sc1 lds
    s_cselect_b32 s10, s14, s10
    buffer_load_dwordx4 v13, s[4:7], s8 offen offset:3072 sc1 lds
    s_add_u32 s8, s8, 0
    s_cmp_eq_u32 s8, 1
    s_cselect_b32 s8, 0, s8
    s_add_u32 s10, s10, 16384
    s_mul_i32 s8, s58, 65536
    s_waitcnt vmcnt(12)
    s_cmp_lg_u32 s54, 0
    s_cbranch_scc1 gg_26
    s_waitcnt vmcnt(12)
    v_cmp_ne_u32 s[20:21], v40, v244
    v_cmp_ne_u32 vcc, v41, v244
    s_or_b64 s[20:21], s[20:21], vcc
    v_cmp_ne_u32 vcc, v42, v244
    s_or_b64 s[20:21], s[20:21], vcc
    v_cmp_ne_u32 vcc, v43, v244
    s_or_b64 s[20:21], s[20:21], vcc
    s_cmp_eq_u64 s[20:21], 0
    s_cbranch_scc1 gg_26
    buffer_load_dwordx4 v[40:43], v37, s[64:67], 0 offen sc1
    s_mov_b32 s36, 100000
pt_28:
    s_waitcnt vmcnt(0)
    v_cmp_ne_u32 s[20:21], v40, v244
    v_cmp_ne_u32 vcc, v41, v244
    s_or_b64 s[20:21], s[20:21], vcc
    v_cmp_ne_u32 vcc, v42, v244
    s_or_b64 s[20:21], s[20:21], vcc
    v_cmp_ne_u32 vcc, v43, v244
    s_or_b64 s[20:21], s[20:21], vcc
    s_cmp_eq_u64 s[20:21], 0
    s_cbranch_scc1 pd_27
    s_sub_u32 s36, s36, 1
    s_cbranch_scc1 pd_27
    s_mov_b32 s20, 40
dl_29:
    s_sub_u32 s20, s20, 1
    s_cbranch_scc0 dl_29
    buffer_load_dwordx4 v[40:43], v37, s[64:67], 0 offen sc1
    s_branch pt_28
pd_27:
gg_26:
    s_barrier
    s_mov_b32 m0, s10
    s_add_u32 s10, s10, 16384
    buffer_load_dwordx4 v28, s[60:63], s8 offen sc1 lds
    buffer_load_dwordx4 v29, s[60:63], s8 offen offset:1024 sc1 lds
    s_cmp_ge_u32 s10, s15
    buffer_load_dwordx4 v30, s[60:63], s8 offen offset:2048 sc1 lds
    s_cselect_b32 s10, s14, s10
    buffer_load_dwordx4 v31, s[60:63], s8 offen offset:3072 sc1 lds
    s_add_u32 s8, s8, 65536
    s_cmp_eq_u32 s8, 1441792
    s_cselect_b32 s8, 0, s8
    s_mov_b32 m0, s10
    s_add_u32 s10, s10, 16384
    buffer_load_dwordx4 v28, s[60:63], s8 offen sc1 lds
    buffer_load_dwordx4 v29, s[60:63], s8 offen offset:1024 sc1 lds
    s_cmp_ge_u32 s10, s15
    buffer_load_dwordx4 v30, s[60:63], s8 offen offset:2048 sc1 lds
    s_cselect_b32 s10, s14, s10
    buffer_load_dwordx4 v31, s[60:63], s8 offen offset:3072 sc1 lds
    s_add_u32 s8, s8, 65536
    s_cmp_eq_u32 s8, 1441792
    s_cselect_b32 s8, 0, s8
    s_waitcnt vmcnt(12)
    s_barrier
    s_mov_b32 m0, s10
    s_add_u32 s10, s10, 16384
    buffer_load_dwordx4 v28, s[60:63], s8 offen sc1 lds
    buffer_load_dwordx4 v29, s[60:63], s8 offen offset:1024 sc1 lds
    s_cmp_ge_u32 s10, s15
    buffer_load_dwordx4 v30, s[60:63], s8 offen offset:2048 sc1 lds
    s_cselect_b32 s10, s14, s10
    buffer_load_dwordx4 v31, s[60:63], s8 offen offset:3072 sc1 lds
    s_add_u32 s8, s8, 65536
    s_cmp_eq_u32 s8, 1441792
    s_cselect_b32 s8, 0, s8
    s_mov_b32 m0, s10
    s_add_u32 s10, s10, 16384
    buffer_load_dwordx4 v28, s[60:63], s8 offen sc1 lds
    buffer_load_dwordx4 v29, s[60:63], s8 offen offset:1024 sc1 lds
    s_cmp_ge_u32 s10, s15
    buffer_load_dwordx4 v30, s[60:63], s8 offen offset:2048 sc1 lds
    s_cselect_b32 s10, s14, s10
    buffer_load_dwordx4 v31, s[60:63], s8 offen offset:3072 sc1 lds
    s_add_u32 s8, s8, 65536
    s_cmp_eq_u32 s8, 1441792
    s_cselect_b32 s8, 0, s8
    s_mov_b32 s11, 8
ll_31:
    s_waitcnt vmcnt(16)
    s_barrier
    s_mov_b32 m0, s10
    s_add_u32 s10, s10, 16384
    buffer_load_dwordx4 v28, s[60:63], s8 offen sc1 lds
    buffer_load_dwordx4 v29, s[60:63], s8 offen offset:1024 sc1 lds
    s_cmp_ge_u32 s10, s15
    buffer_load_dwordx4 v30, s[60:63], s8 offen offset:2048 sc1 lds
    s_cselect_b32 s10, s14, s10
    buffer_load_dwordx4 v31, s[60:63], s8 offen offset:3072 sc1 lds
    s_add_u32 s8, s8, 65536
    s_cmp_eq_u32 s8, 1441792
    s_cselect_b32 s8, 0, s8
    s_mov_b32 m0, s10
    s_add_u32 s10, s10, 16384
    buffer_load_dwordx4 v28, s[60:63], s8 offen sc1 lds
    buffer_load_dwordx4 v29, s[60:63], s8 offen offset:1024 sc1 lds
    s_cmp_ge_u32 s10, s15
    buffer_load_dwordx4 v30, s[60:63], s8 offen offset:2048 sc1 lds
    s_cselect_b32 s10, s14, s10
    buffer_load_dwordx4 v31, s[60:63], s8 offen offset:3072 sc1 lds
    s_add_u32 s8, s8, 65536
    s_cmp_eq_u32 s8, 1441792
    s_cselect_b32 s8, 0, s8
    s_sub_u32 s11, s11, 1
    s_cbranch_scc0 ll_31
    s_waitcnt vmcnt(16)
    s_barrier
    s_waitcnt vmcnt(8)
    s_barrier
    s_waitcnt vmcnt(0)
    s_barrier
    s_endpgm
l_B:
    v_mul_u32_u24 v9, 2752, v6
    s_lshl_b32 s20, s49, 7
    v_add3_u32 v20, v9, v7, s20
    v_add_u32 v21, 20992, v20
    v_add_u32 v22, 41984, v20
    v_add_u32 v23, 62976, v20
    v_mul_u32_u24 v9, 4096, v6
    s_lshl_b32 s20, s52, 7
    v_add3_u32 v24, v9, v7, s20
    v_add_u32 v25, 31744, v24
    v_add_u32 v26, 63488, v24
    v_add_u32 v27, 95232, v24
    s_mov_b32 s24, s88
    s_mov_b32 s25, s89
    s_mov_b32 s26, 5636096
    s_mov_b32 s27, 0x00020000
    s_add_u32 s28, s16, 4194304
    s_addc_u32 s29, s17, 0
    s_mov_b32 s30, 4194304
    s_mov_b32 s31, 0x00020000
    s_mov_b32 s60, s92
    s_mov_b32 s61, s93
    s_mov_b32 s62, 5636096
    s_mov_b32 s63, 0x00020000
    s_lshl_b32 s20, s52, 1
    s_add_u32 s20, s20, s54
    s_lshl_b32 s20, s20, 16
    v_lshl_add_u32 v28, v1, 4, s20
    v_mov_b32 v29, v28
    v_mov_b32 v30, v28
    v_mov_b32 v31, v28
    s_and_b32 s26, s26, s50
    v_and_b32 v2, 3, v1
    v_mul_u32_u24 v35, 260, v2
    s_lshl_b32 s20, s3, 8
    v_lshl_add_u32 v34, v1, 2, s20
    v_mov_b32 v32, 0
    s_mov_b32 s59, 0
    s_mov_b32 s55, 100000
    s_lshr_b32 s20, s52, 1
    s_lshl_b32 s20, s20, 8
    s_add_u32 s20, s20, 24576
    v_and_b32 v2, 15, v1
    v_lshl_add_u32 v37, v2, 4, s20
    s_waitcnt vmcnt(24)
    s_barrier
    v_add_u32 v244, 0x9e3779b9, v244
    s_waitcnt vmcnt(12)
    s_barrier
    s_mov_b32 m0, s10
    s_add_u32 s38, s10, s37
    buffer_load_dwordx4 v10, s[4:7], s8 offen lds
    buffer_load_dwordx4 v11, s[4:7], s8 offen offset:1024 lds
    s_add_u32 s10, s10, 24576
    buffer_load_dwordx4 v12, s[4:7], s8 offen offset:2048 lds
    s_cmp_ge_u32 s10, s15
    buffer_load_dwordx4 v13, s[4:7], s8 offen offset:3072 lds
    s_mov_b32 m0, s38
    s_cselect_b32 s10, s14, s10
    buffer_load_dwordx4 v14, s[32:35], s8 offen lds
    buffer_load_dwordx4 v15, s[32:35], s8 offen offset:1024 lds
    s_add_u32 s8, s8, 128
    s_and_b32 s8, s8, 1023
    s_mov_b32 m0, s10
    s_add_u32 s38, s10, s37
    buffer_load_dwordx4 v10, s[4:7], s8 offen lds
    buffer_load_dwordx4 v11, s[4:7], s8 offen offset:1024 lds
    s_add_u32 s10, s10, 24576
    buffer_load_dwordx4 v12, s[4:7], s8 offen offset:2048 lds
    s_cmp_ge_u32 s10, s15
    buffer_load_dwordx4 v13, s[4:7], s8 offen offset:3072 lds
    s_mov_b32 m0, s38
    s_cselect_b32 s10, s14, s10
    buffer_load_dwordx4 v14, s[32:35], s8 offen lds
    buffer_load_dwordx4 v15, s[32:35], s8 offen offset:1024 lds
    s_add_u32 s8, s8, 128
    s_and_b32 s8, s8, 1023
    s_mov_b32 s10, s14
    s_add_u32 s15, s14, 131072
    s_mul_i32 s8, s56, 176128
    s_waitcnt vmcnt(12)
    s_barrier
    s_mov_b32 m0, s10
    s_add_u32 s10, s10, 16384
    buffer_load_dwordx4 v20, s[24:27], s8 offen lds
    buffer_load_dwordx4 v21, s[24:27], s8 offen offset:1024 lds
    s_cmp_ge_u32 s10, s15
    buffer_load_dwordx4 v22, s[24:27], s8 offen offset:2048 lds
    s_cselect_b32 s10, s14, s10
    buffer_load_dwordx4 v23, s[24:27], s8 offen offset:3072 lds
    s_add_u32 s8, s8, 176128
    s_cmp_eq_u32 s8, 5636096
    s_cselect_b32 s8, 0, s8
    s_mov_b32 m0, s10
    s_add_u32 s10, s10, 16384
    buffer_load_dwordx4 v20, s[24:27], s8 offen lds
    buffer_load_dwordx4 v21, s[24:27], s8 offen offset:1024 lds
    s_cmp_ge_u32 s10, s15
    buffer_load_dwordx4 v22, s[24:27], s8 offen offset:2048 lds
    s_cselect_b32 s10, s14, s10
    buffer_load_dwordx4 v23, s[24:27], s8 offen offset:3072 lds
    s_add_u32 s8, s8, 176128
    s_cmp_eq_u32 s8, 5636096
    s_cselect_b32 s8, 0, s8
    s_mov_b32 m0, s10
    s_add_u32 s10, s10, 16384
    buffer_load_dwordx4 v20, s[24:27], s8 offen lds
    buffer_load_dwordx4 v21, s[24:27], s8 offen offset:1024 lds
    s_cmp_ge_u32 s10, s15
    buffer_load_dwordx4 v22, s[24:27], s8 offen offset:2048 lds
    s_cselect_b32 s10, s14, s10
    buffer_load_dwordx4 v23, s[24:27], s8 offen offset:3072 lds
    s_add_u32 s8, s8, 176128
    s_cmp_eq_u32 s8, 5636096
    s_cselect_b32 s8, 0, s8
    s_waitcnt vmcnt(12)
    s_barrier
    s_mov_b32 m0, s10
    s_add_u32 s10, s10, 16384
    buffer_load_dwordx4 v20, s[24:27], s8 offen lds
    buffer_load_dwordx4 v21, s[24:27], s8 offen offset:1024 lds
    s_cmp_ge_u32 s10, s15
    buffer_load_dwordx4 v22, s[24:27], s8 offen offset:2048 lds
    s_cselect_b32 s10, s14, s10
    buffer_load_dwordx4 v23, s[24:27], s8 offen offset:3072 lds
    s_add_u32 s8, s8, 176128
    s_cmp_eq_u32 s8, 5636096
    s_cselect_b32 s8, 0, s8
    s_mov_b32 m0, s10
    s_add_u32 s10, s10, 16384
    buffer_load_dwordx4 v20, s[24:27], s8 offen lds
    buffer_load_dwordx4 v21, s[24:27], s8 offen offset:1024 lds
    s_cmp_ge_u32 s10, s15
    buffer_load_dwordx4 v22, s[24:27], s8 offen offset:2048 lds
    s_cselect_b32 s10, s14, s10
    buffer_load_dwordx4 v23, s[24:27], s8 offen offset:3072 lds
    s_add_u32 s8, s8, 176128
    s_cmp_eq_u32 s8, 5636096
    s_cselect_b32 s8, 0, s8
    s_mov_b32 m0, s10
    s_add_u32 s10, s10, 16384
    buffer_load_dwordx4 v20, s[24:27], s8 offen lds
    buffer_load_dwordx4 v21, s[24:27], s8 offen offset:1024 lds
    s_cmp_ge_u32 s10, s15
    buffer_load_dwordx4 v22, s[24:27], s8 offen offset:2048 lds
    s_cselect_b32 s10, s14, s10
    buffer_load_dwordx4 v23, s[24:27], s8 offen offset:3072 lds
    s_add_u32 s8, s8, 176128
    s_cmp_eq_u32 s8, 5636096
    s_cselect_b32 s8, 0, s8
    s_barrier
    s_lshl_b32 s20, s52, 16
    s_lshl_b32 s21, s54, 15
    s_add_u32 s20, s20, s21
    s_lshl_b32 s21, s51, 7
    s_add_u32 s20, s20, s21
    v_add_u32 v10, s20, v16
    v_add_u32 v11, s20, v17
    v_add_u32 v12, 14336, v10
    v_add_u32 v13, 14336, v11
    s_mov_b32 s11, 10
ll_32:
    s_waitcnt vmcnt(16)
    s_barrier
    s_mov_b32 m0, s10
    s_add_u32 s10, s10, 16384
    buffer_load_dwordx4 v20, s[24:27], s8 offen lds
    buffer_load_dwordx4 v21, s[24:27], s8 offen offset:1024 lds
    s_cmp_ge_u32 s10, s15
    buffer_load_dwordx4 v22, s[24:27], s8 offen offset:2048 lds
    s_cselect_b32 s10, s14, s10
    buffer_load_dwordx4 v23, s[24:27], s8 offen offset:3072 lds
    s_add_u32 s8, s8, 176128
    s_cmp_eq_u32 s8, 5636096
    s_cselect_b32 s8, 0, s8
    s_mov_b32 m0, s10
    s_add_u32 s10, s10, 16384
    buffer_load_dwordx4 v20, s[24:27], s8 offen lds
    buffer_load_dwordx4 v21, s[24:27], s8 offen offset:1024 lds
    s_cmp_ge_u32 s10, s15
    buffer_load_dwordx4 v22, s[24:27], s8 offen offset:2048 lds
    s_cselect_b32 s10, s14, s10
    buffer_load_dwordx4 v23, s[24:27], s8 offen offset:3072 lds
    s_add_u32 s8, s8, 176128
    s_cmp_eq_u32 s8, 5636096
    s_cselect_b32 s8, 0, s8
    s_sub_u32 s11, s11, 1
    s_cbranch_scc0 ll_32
    buffer_load_dwordx4 v[40:43], v37, s[64:67], 0 offen sc1
    s_mov_b32 s11, 1
ll_33:
    s_waitcnt vmcnt(16)
    s_barrier
    s_mov_b32 m0, s10
    s_add_u32 s10, s10, 16384
    buffer_load_dwordx4 v20, s[24:27], s8 offen lds
    buffer_load_dwordx4 v21, s[24:27], s8 offen offset:1024 lds
    s_cmp_ge_u32 s10, s15
    buffer_load_dwordx4 v22, s[24:27], s8 offen offset:2048 lds
    s_cselect_b32 s10, s14, s10
    buffer_load_dwordx4 v23, s[24:27], s8 offen offset:3072 lds
    s_add_u32 s8, s8, 176128
    s_cmp_eq_u32 s8, 5636096
    s_cselect_b32 s8, 0, s8
    s_mov_b32 m0, s10
    s_add_u32 s10, s10, 16384
    buffer_load_dwordx4 v20, s[24:27], s8 offen lds
    buffer_load_dwordx4 v21, s[24:27], s8 offen offset:1024 lds
    s_cmp_ge_u32 s10, s15
    buffer_load_dwordx4 v22, s[24:27], s8 offen offset:2048 lds
    s_cselect_b32 s10, s14, s10
    buffer_load_dwordx4 v23, s[24:27], s8 offen offset:3072 lds
    s_add_u32 s8, s8, 176128
    s_cmp_eq_u32 s8, 5636096
    s_cselect_b32 s8, 0, s8
    s_sub_u32 s11, s11, 1
    s_cbranch_scc0 ll_33
    s_mul_i32 s8, s57, 4096
    s_waitcnt vmcnt(16)
    v_cmp_ne_u32 s[20:21], v40, v244
    v_cmp_ne_u32 vcc, v41, v244
    s_or_b64 s[20:21], s[20:21], vcc
    v_cmp_ne_u32 vcc, v42, v244
    s_or_b64 s[20:21], s[20:21], vcc
    v_cmp_ne_u32 vcc, v43, v244
    s_or_b64 s[20:21], s[20:21], vcc
    s_cmp_eq_u64 s[20:21], 0
    s_cbranch_scc1 lb_fast
    s_barrier
    s_waitcnt vmcnt(8)
    s_barrier
    buffer_load_dwordx4 v[40:43], v37, s[64:67], 0 offen sc1
    s_waitcnt vmcnt(1)
    s_barrier
    s_mov_b32 s36, 100000
pt_35:
    s_waitcnt vmcnt(0)
    v_cmp_ne_u32 s[20:21], v40, v244
    v_cmp_ne_u32 vcc, v41, v244
    s_or_b64 s[20:21], s[20:21], vcc
    v_cmp_ne_u32 vcc, v42, v244
    s_or_b64 s[20:21], s[20:21], vcc
    v_cmp_ne_u32 vcc, v43, v244
    s_or_b64 s[20:21], s[20:21], vcc
    s_cmp_eq_u64 s[20:21], 0
    s_cbranch_scc1 pd_34
    s_sub_u32 s36, s36, 1
    s_cbranch_scc1 pd_34
    s_mov_b32 s20, 40
dl_36:
    s_sub_u32 s20, s20, 1
    s_cbranch_scc0 dl_36
    buffer_load_dwordx4 v[40:43], v37, s[64:67], 0 offen sc1
    s_branch pt_35
pd_34:
    s_mov_b32 s11, 5
lb_burst:
    s_mov_b32 m0, s10
    s_add_u32 s10, s10, 16384
    buffer_load_dwordx4 v28, s[28:31], s8 offen sc1 lds
    buffer_load_dwordx4 v29, s[28:31], s8 offen offset:1024 sc1 lds
    s_cmp_ge_u32 s10, s15
    buffer_load_dwordx4 v30, s[28:31], s8 offen offset:2048 sc1 lds
    s_cselect_b32 s10, s14, s10
    buffer_load_dwordx4 v31, s[28:31], s8 offen offset:3072 sc1 lds
    s_add_u32 s8, s8, 4096
    s_cmp_eq_u32 s8, 65536
    s_cselect_b32 s8, 0, s8
    s_sub_u32 s11, s11, 1
    s_cbranch_scc0 lb_burst
    s_branch lb_join
lb_fast:
    s_mov_b32 s11, 2
ll_37:
    s_waitcnt vmcnt(16)
    s_barrier
    s_mov_b32 m0, s10
    s_add_u32 s10, s10, 16384
    buffer_load_dwordx4 v28, s[28:31], s8 offen sc1 lds
    buffer_load_dwordx4 v29, s[28:31], s8 offen offset:1024 sc1 lds
    s_cmp_ge_u32 s10, s15
    buffer_load_dwordx4 v30, s[28:31], s8 offen offset:2048 sc1 lds
    s_cselect_b32 s10, s14, s10
    buffer_load_dwordx4 v31, s[28:31], s8 offen offset:3072 sc1 lds
    s_add_u32 s8, s8, 4096
    s_cmp_eq_u32 s8, 65536
    s_cselect_b32 s8, 0, s8
    s_mov_b32 m0, s10
    s_add_u32 s10, s10, 16384
    buffer_load_dwordx4 v28, s[28:31], s8 offen sc1 lds
    buffer_load_dwordx4 v29, s[28:31], s8 offen offset:1024 sc1 lds
    s_cmp_ge_u32 s10, s15
    buffer_load_dwordx4 v30, s[28:31], s8 offen offset:2048 sc1 lds
    s_cselect_b32 s10, s14, s10
    buffer_load_dwordx4 v31, s[28:31], s8 offen offset:3072 sc1 lds
    s_add_u32 s8, s8, 4096
    s_cmp_eq_u32 s8, 65536
    s_cselect_b32 s8, 0, s8
    s_sub_u32 s11, s11, 1
    s_cbranch_scc0 ll_37
lb_join:
    s_lshl_b32 s20, s52, 7
    v_lshl_add_u32 v44, v1, 12, s20
    s_lshl1_add_u32 s20, s54, s58
    s_cmp_ge_u32 s20, 22
    s_cselect_b32 s21, 22, 0
    s_sub_u32 s21, s20, s21
    s_lshl_b32 s21, s21, 18
    buffer_load_dword v45, v44, s[60:63], s21 offen
    s_add_u32 s20, s20, 1
    s_cmp_ge_u32 s20, 22
    s_cselect_b32 s21, 22, 0
    s_sub_u32 s21, s20, s21
    s_lshl_b32 s21, s21, 18
    buffer_load_dword v45, v44, s[60:63], s21 offen
    s_add_u32 s20, s20, 1
    s_mov_b32 s11, 2
ll_38:
    s_waitcnt vmcnt(18)
    s_barrier
    s_mov_b32 m0, s10
    s_add_u32 s10, s10, 16384
    buffer_load_dwordx4 v28, s[28:31], s8 offen sc1 lds
    buffer_load_dwordx4 v29, s[28:31], s8 offen offset:1024 sc1 lds
    s_cmp_ge_u32 s10, s15
    buffer_load_dwordx4 v30, s[28:31], s8 offen offset:2048 sc1 lds
    s_cselect_b32 s10, s14, s10
    buffer_load_dwordx4 v31, s[28:31], s8 offen offset:3072 sc1 lds
    s_add_u32 s8, s8, 4096
    s_cmp_eq_u32 s8, 65536
    s_cselect_b32 s8, 0, s8
    s_mov_b32 m0, s10
    s_add_u32 s10, s10, 16384
    buffer_load_dwordx4 v28, s[28:31], s8 offen sc1 lds
    buffer_load_dwordx4 v29, s[28:31], s8 offen offset:1024 sc1 lds
    s_cmp_ge_u32 s10, s15
    buffer_load_dwordx4 v30, s[28:31], s8 offen offset:2048 sc1 lds
    s_cselect_b32 s10, s14, s10
    buffer_load_dwordx4 v31, s[28:31], s8 offen offset:3072 sc1 lds
    s_add_u32 s8, s8, 4096
    s_cmp_eq_u32 s8, 65536
    s_cselect_b32 s8, 0, s8
    s_sub_u32 s11, s11, 1
    s_cbranch_scc0 ll_38
    s_mov_b32 s11, 1
ll_39:
    s_waitcnt vmcnt(16)
    s_barrier
    s_mov_b32 m0, s10
    s_add_u32 s10, s10, 16384
    buffer_load_dwordx4 v28, s[28:31], s8 offen sc1 lds
    buffer_load_dwordx4 v29, s[28:31], s8 offen offset:1024 sc1 lds
    s_cmp_ge_u32 s10, s15
    buffer_load_dwordx4 v30, s[28:31], s8 offen offset:2048 sc1 lds
    s_cselect_b32 s10, s14, s10
    buffer_load_dwordx4 v31, s[28:31], s8 offen offset:3072 sc1 lds
    s_add_u32 s8, s8, 4096
    s_cmp_eq_u32 s8, 65536
    s_cselect_b32 s8, 0, s8
    s_mov_b32 m0, s10
    s_add_u32 s10, s10, 16384
    buffer_load_dwordx4 v28, s[28:31], s8 offen sc1 lds
    buffer_load_dwordx4 v29, s[28:31], s8 offen offset:1024 sc1 lds
    s_cmp_ge_u32 s10, s15
    buffer_load_dwordx4 v30, s[28:31], s8 offen offset:2048 sc1 lds
    s_cselect_b32 s10, s14, s10
    buffer_load_dwordx4 v31, s[28:31], s8 offen offset:3072 sc1 lds
    s_add_u32 s8, s8, 4096
    s_cmp_eq_u32 s8, 65536
    s_cselect_b32 s8, 0, s8
    s_sub_u32 s11, s11, 1
    s_cbranch_scc0 ll_39
    s_waitcnt vmcnt(16)
    s_barrier
    s_mov_b32 s8, 0
    s_mov_b32 m0, s10
    s_add_u32 s10, s10, 16384
    buffer_load_dwordx4 v10, s[4:7], s8 offen lds
    buffer_load_dwordx4 v11, s[4:7], s8 offen offset:1024 lds
    s_cmp_ge_u32 s10, s15
    buffer_load_dwordx4 v12, s[4:7], s8 offen offset:2048 lds
    s_cselect_b32 s10, s14, s10
    buffer_load_dwordx4 v13, s[4:7], s8 offen offset:3072 lds
    s_add_u32 s8, s8, 0
    s_cmp_eq_u32 s8, 1
    s_cselect_b32 s8, 0, s8
    s_add_u32 s10, s10, 16384
    s_mul_i32 s8, s58, 262144
    s_mov_b32 s11, 1
ll_41:
    s_waitcnt vmcnt(12)
    s_barrier
    s_mov_b32 m0, s10
    s_add_u32 s10, s10, 16384
    buffer_load_dwordx4 v24, s[60:63], s8 offen lds
    buffer_load_dwordx4 v25, s[60:63], s8 offen offset:1024 lds
    s_cmp_ge_u32 s10, s15
    buffer_load_dwordx4 v26, s[60:63], s8 offen offset:2048 lds
    s_cselect_b32 s10, s14, s10
    buffer_load_dwordx4 v27, s[60:63], s8 offen offset:3072 lds
    s_add_u32 s8, s8, 262144
    s_cmp_eq_u32 s8, 5767168
    s_cselect_b32 s8, 0, s8
    s_mov_b32 m0, s10
    s_add_u32 s10, s10, 16384
    buffer_load_dwordx4 v24, s[60:63], s8 offen lds
    buffer_load_dwordx4 v25, s[60:63], s8 offen offset:1024 lds
    s_cmp_ge_u32 s10, s15
    buffer_load_dwordx4 v26, s[60:63], s8 offen offset:2048 lds
    s_cselect_b32 s10, s14, s10
    buffer_load_dwordx4 v27, s[60:63], s8 offen offset:3072 lds
    s_add_u32 s8, s8, 262144
    s_cmp_eq_u32 s8, 5767168
    s_cselect_b32 s8, 0, s8
    s_sub_u32 s11, s11, 1
    s_cbranch_scc0 ll_41
    s_mov_b32 s11, 8
ll_42:
    s_waitcnt vmcnt(16)
    s_barrier
    s_mov_b32 m0, s10
    s_add_u32 s10, s10, 16384
    buffer_load_dwordx4 v24, s[60:63], s8 offen lds
    buffer_load_dwordx4 v25, s[60:63], s8 offen offset:1024 lds
    s_cmp_ge_u32 s10, s15
    buffer_load_dwordx4 v26, s[60:63], s8 offen offset:2048 lds
    s_cselect_b32 s10, s14, s10
    buffer_load_dwordx4 v27, s[60:63], s8 offen offset:3072 lds
    s_add_u32 s8, s8, 262144
    s_cmp_eq_u32 s8, 5767168
    s_cselect_b32 s8, 0, s8
    s_mov_b32 m0, s10
    s_add_u32 s10, s10, 16384
    buffer_load_dwordx4 v24, s[60:63], s8 offen lds
    buffer_load_dwordx4 v25, s[60:63], s8 offen offset:1024 lds
    s_cmp_ge_u32 s10, s15
    buffer_load_dwordx4 v26, s[60:63], s8 offen offset:2048 lds
    s_cselect_b32 s10, s14, s10
    buffer_load_dwordx4 v27, s[60:63], s8 offen offset:3072 lds
    s_add_u32 s8, s8, 262144
    s_cmp_eq_u32 s8, 5767168
    s_cselect_b32 s8, 0, s8
    s_sub_u32 s11, s11, 1
    s_cbranch_scc0 ll_42
    s_waitcnt vmcnt(16)
    s_barrier
    s_waitcnt vmcnt(8)
    s_barrier
    s_waitcnt vmcnt(0)
    s_barrier
    s_endpgm
k_end:
    s_endpgm
.section .rodata,"a"
.p2align 6
.amdhsa_kernel recurrent_scan__ssm_conv_s5__mixer_token_mlp__prompt_kernel
  .amdhsa_next_free_vgpr 256
  .amdhsa_next_free_sgpr 102
  .amdhsa_accum_offset 256
  .amdhsa_group_segment_fixed_size 0
  .amdhsa_kernarg_size 136
  .amdhsa_user_sgpr_count 2
  .amdhsa_user_sgpr_kernarg_segment_ptr 1
  .amdhsa_system_sgpr_workgroup_id_x 1
  .amdhsa_float_denorm_mode_32 3
.end_amdhsa_kernel
```
